```python
import torch

def _softmax(x, axis=-1):
    return torch.softmax(x, dim=axis)

def _gelu(x):
    return torch.nn.functional.gelu(x, approximate='tanh')

def _silu(x):
    return torch.nn.functional.silu(x)

def _sigmoid(x):
    return torch.sigmoid(x)

def _layernorm(x, axis=-1, eps=1e-05):
    m = x.mean(dim=axis, keepdim=True)
    v = x.var(dim=axis, keepdim=True, unbiased=False)
    return (x - m) / torch.sqrt(v + eps)

def _scatter_add(tgt, idx, src, axis=0):
    return tgt.clone().index_add_(axis, idx, src)

def _segment_sum(src, seg, n):
    out = torch.zeros((n,) + src.shape[1:], dtype=src.dtype)
    return out.index_add_(0, seg, src)

def _pad(x, pw):
    flat = tuple((v for pair in reversed(pw) for v in pair))
    return torch.nn.functional.pad(x, flat)
kernel_name = 'adaLN_cond__sliding_block_cached__mixer_channel_mlp__decode'

def setup_inputs():

    _w = lambda a: (lambda t: t.to(torch.bfloat16) if t.is_floating_point() else t)(torch.as_tensor(a))

    def _A_setup():
        B, Sq, D = (1, 1, 576)
        Hq, Hkv, Sk, Dh = (32, 16, 32768, 128)
        assert Hq % Hkv == 0, (Hq, Hkv)
        return {'x': _w((lambda *s: torch.randn(*s, dtype=torch.bfloat16) * 0.1)(B, Sq, D)), 'k_cache': _w((lambda *s: torch.randn(*s, dtype=torch.bfloat16) * 0.8)(B, Hkv, Sk, Dh)), 'v_cache': _w((lambda *s: torch.randn(*s, dtype=torch.bfloat16) * 0.8)(B, Hkv, Sk, Dh)), 'wq': _w((lambda *s: torch.randn(*s, dtype=torch.bfloat16) * 0.8)(D, Hq * Dh) * D ** (-0.5)), 'wo': _w((lambda *s: torch.randn(*s, dtype=torch.bfloat16) * 0.8)(Hq * Dh, D) * (Hq * Dh) ** (-0.5))}
    _A_in = _A_setup()

    def _B_setup():
        B, S, D, F = (1, 1, 576, 4608)
        return {'x': _w((lambda *s: torch.randn(*s, dtype=torch.bfloat16) * 0.1)(B, S, D)), 'w1': _w((lambda *s: torch.randn(*s, dtype=torch.bfloat16) * 3.2)(D, F) * D ** (-0.5)), 'b1': _w((lambda *s: torch.randn(*s, dtype=torch.bfloat16) * 3.2)(F)), 'w2': _w((lambda *s: torch.randn(*s, dtype=torch.bfloat16) * 1.6)(F, D) * F ** (-0.5)), 'b2': _w((lambda *s: torch.randn(*s, dtype=torch.bfloat16) * 1.6)(D))}
    _B_in = _B_setup()
    return {'A_x': _A_in['x'], 'A_k_cache': _A_in['k_cache'], 'A_v_cache': _A_in['v_cache'], 'A_wq': _A_in['wq'], 'A_wo': _A_in['wo'], 'B_x': _B_in['x'], 'B_w1': _B_in['w1'], 'B_b1': _B_in['b1'], 'B_w2': _B_in['w2'], 'B_b2': _B_in['b2'], 'c': _w((lambda *s: torch.randn(*s, dtype=torch.bfloat16) * 0.4)(1, 576) * 8.0), 'w_mod': _w((lambda *s: torch.randn(*s, dtype=torch.bfloat16) * 0.4)(576, 6 * 576) * 576 ** (-0.5) * 8.0)}

def reference(A_x, A_k_cache, A_v_cache, A_wq, A_wo, B_x, B_w1, B_b1, B_w2, B_b2, c, w_mod):

    def _A_ref(x, k_cache, v_cache, wq, wo):
        B, Sq, D = x.shape
        Hq, Dh = (32, 128)
        Hkv, Sk = (k_cache.shape[1], k_cache.shape[2])
        W = min(4096, max(256, Sk // 4))
        rep = Hq // Hkv
        q = (lambda x, *d: x.permute(*d))((x @ wq).reshape(B, Sq, Hq, Dh), 0, 2, 1, 3)
        k = (lambda x, n, axis: torch.repeat_interleave(x, n, dim=axis))(k_cache[:, :, Sk - W:, :], rep, axis=1)
        v = (lambda x, n, axis: torch.repeat_interleave(x, n, dim=axis))(v_cache[:, :, Sk - W:, :], rep, axis=1)
        scores = torch.einsum('bhqd,bhkd->bhqk', q, k) * Dh ** (-0.5)
        p = _softmax(scores, axis=-1)
        o = torch.einsum('bhqk,bhkd->bhqd', p, v)
        return (lambda x, *d: x.permute(*d))(o, 0, 2, 1, 3).reshape(B, Sq, Hq * Dh) @ wo

    def _B_ref(x, w1, b1, w2, b2):
        y = _layernorm(x, axis=-1)
        h = _gelu(torch.einsum('bsd,df->bsf', y, w1) + b1)
        return torch.einsum('bsf,fd->bsd', h, w2) + b2
    x = A_x
    mod = (_silu(c) @ w_mod).reshape(c.shape[0], 6, 1, -1)
    sa, ca, ga, sb, cb, gb = (mod[:, 0].clone(), mod[:, 1].clone(), mod[:, 2].clone(), mod[:, 3].clone(), mod[:, 4].clone(), mod[:, 5].clone())
    h = _layernorm(x, axis=-1) * (1 + ca) + sa
    x = x + ga * _A_ref(h, A_k_cache, A_v_cache, A_wq, A_wo)
    h = _layernorm(x, axis=-1) * (1 + cb) + sb
    x = x + gb * _B_ref(h, B_w1, B_b1, B_w2, B_b2)
    return x
```

```asm
; @launch grid=(256,1,1) block=(512,1,1) lds=20736
.amdgcn_target "amdgcn-amd-amdhsa--gfx950"
.text
.globl adaLN_cond__sliding_block_cached__mixer_channel_mlp__decode_kernel
.p2align 8
.type adaLN_cond__sliding_block_cached__mixer_channel_mlp__decode_kernel,@function
adaLN_cond__sliding_block_cached__mixer_channel_mlp__decode_kernel:
    s_cmp_ge_u32 s2, 256
    s_cbranch_scc1 L_end
    s_load_dwordx16 s[8:23], s[0:1], 0
    s_load_dwordx8 s[24:31], s[0:1], 64
    s_load_dwordx4 s[32:35], s[0:1], 96
    s_load_dwordx2 s[36:37], s[0:1], 112
    v_lshrrev_b32 v1, 6, v0
    v_and_b32 v0, 63, v0
    v_readfirstlane_b32 s40, v1
    s_and_b32 s41, s2, 7
    s_lshr_b32 s42, s2, 3
    v_and_b32 v1, 15, v0
    v_lshrrev_b32 v2, 4, v0
    s_cmp_lt_u32 s42, 9
    s_cbranch_scc0 L_a
    v_lshl_add_u32 v8, v1, 2, v2
    s_mov_b32 s78, 0x00ff00ff
    s_mov_b32 s79, 0
    s_cmp_ge_u32 s40, 4
    s_cbranch_scc0 L_wq
L_wo0:
    v_lshrrev_b32 v3, 3, v1
    v_lshl_add_u32 v3, v2, 1, v3
    v_and_b32 v4, 7, v1
    v_lshlrev_b32 v4, 4, v4
    s_mul_i32 s45, s41, 9
    s_add_u32 s45, s45, s42
    s_and_b32 s46, s45, 3
    s_lshr_b32 s45, s45, 2
    v_mov_b32 v6, 0
    v_mov_b32 v10, 0
    v_mov_b32 v11, 0
    v_mov_b32 v12, 0
    v_mov_b32 v13, 0
    s_cmp_eq_u32 s40, 7
    s_cbranch_scc0 L_wo_noinit
    ds_write_b128 v6, v[10:13] offset:3328
L_wo_noinit:
    s_waitcnt lgkmcnt(0)
    s_mov_b32 s48, s30
    s_mov_b32 s49, s31
    s_mov_b32 s50, 3981312
    s_mov_b32 s51, 0x20000
    s_cmp_eq_u32 s40, 4
    s_cbranch_scc0 L_w_nom
    s_mov_b32 s56, s28
    s_mov_b32 s57, s29
    s_mov_b32 s58, 1152
    s_mov_b32 s59, 0x20000
    s_mul_i32 s38, s46, 288
    v_lshl_add_u32 v6, v0, 1, s38
    buffer_load_ushort v10, v6, s[56:59], 0 offen offset:0
    buffer_load_ushort v11, v6, s[56:59], 0 offen offset:128
    buffer_load_ushort v12, v6, s[56:59], 0 offen offset:256
    v_mul_u32_u24 v6, 6912, v3
    v_add_u32 v6, v6, v4
    s_mul_i32 s38, s46, 995328
    s_lshl_b32 s39, s45, 7
    s_add_u32 s38, s38, s39
    buffer_load_dwordx4 v[16:19], v6, s[48:51], s38 offen nt
    s_add_u32 s38, s38, 55296
    buffer_load_dwordx4 v[20:23], v6, s[48:51], s38 offen nt
    s_add_u32 s38, s38, 55296
    buffer_load_dwordx4 v[24:27], v6, s[48:51], s38 offen nt
    s_add_u32 s38, s38, 55296
    buffer_load_dwordx4 v[28:31], v6, s[48:51], s38 offen nt
    s_add_u32 s38, s38, 55296
    buffer_load_dwordx4 v[32:35], v6, s[48:51], s38 offen nt
    s_add_u32 s38, s38, 55296
    buffer_load_dwordx4 v[36:39], v6, s[48:51], s38 offen nt
    s_add_u32 s38, s38, 55296
    buffer_load_dwordx4 v[40:43], v6, s[48:51], s38 offen nt
    s_add_u32 s38, s38, 55296
    buffer_load_dwordx4 v[44:47], v6, s[48:51], s38 offen nt
    s_add_u32 s38, s38, 55296
    buffer_load_dwordx4 v[48:51], v6, s[48:51], s38 offen nt
    s_add_u32 s38, s38, 55296
    buffer_load_dwordx4 v[52:55], v6, s[48:51], s38 offen nt
    s_add_u32 s38, s38, 55296
    buffer_load_dwordx4 v[56:59], v6, s[48:51], s38 offen nt
    s_add_u32 s38, s38, 55296
    buffer_load_dwordx4 v[60:63], v6, s[48:51], s38 offen nt
    s_add_u32 s38, s38, 55296
    buffer_load_dwordx4 v[64:67], v6, s[48:51], s38 offen nt
    s_add_u32 s38, s38, 55296
    buffer_load_dwordx4 v[68:71], v6, s[48:51], s38 offen nt
    s_add_u32 s38, s38, 55296
    buffer_load_dwordx4 v[72:75], v6, s[48:51], s38 offen nt
    s_add_u32 s38, s38, 55296
    buffer_load_dwordx4 v[76:79], v6, s[48:51], s38 offen nt
    s_add_u32 s38, s38, 55296
    buffer_load_dwordx4 v[80:83], v6, s[48:51], s38 offen nt
    s_add_u32 s38, s38, 55296
    buffer_load_dwordx4 v[84:87], v6, s[48:51], s38 offen nt
L_w_nom:
    s_cmp_eq_u32 s40, 5
    s_cbranch_scc0 L_w_nox
    s_mov_b32 s56, s8
    s_mov_b32 s57, s9
    s_mov_b32 s58, 1152
    s_mov_b32 s59, 0x20000
    v_lshlrev_b32 v6, 4, v0
    v_lshlrev_b32 v7, 2, v0
    buffer_load_dwordx4 v[152:155], v6, s[56:59], 0 offen
    buffer_load_dword v156, v7, s[56:59], 0 offen offset:1024
    v_and_b32 v9, 1, v1
    v_lshl_add_u32 v9, v9, 2, v2
    v_add_u32 v9, 64, v9
    s_mul_i32 s38, s42, 144
    v_lshlrev_b32 v6, 1, v8
    v_lshlrev_b32 v7, 1, v9
    buffer_load_ushort v157, v6, s[56:59], s38 offen
    buffer_load_ushort v158, v7, s[56:59], s38 offen
L_w_nox:
    s_load_dword s43, s[36:37], 0
    s_mov_b32 s60, s36
    s_mov_b32 s61, s37
    s_mov_b32 s62, 3145728
    s_mov_b32 s63, 0x20000
    s_barrier
    s_branch L_wo1
L_wq:
    s_lshl_b32 s38, s42, 2
    s_add_u32 s38, s38, s40
    s_cmp_eq_u32 s38, 32
    s_cbranch_scc0 L_wq_nopf
    s_getpc_b64 s[38:39]
L_pc_6:
    s_sub_u32 s38, s38, L_pc_6-adaLN_cond__sliding_block_cached__mixer_channel_mlp__decode_kernel
    s_subb_u32 s39, s39, 0
    v_lshlrev_b32 v13, 7, v0
    global_load_dword v16, v13, s[38:39]
    v_add_u32 v13, 8192, v13
    global_load_dword v17, v13, s[38:39]
    v_add_u32 v13, 8192, v13
    v_min_u32 v13, L_end-adaLN_cond__sliding_block_cached__mixer_channel_mlp__decode_kernel, v13
    global_load_dword v18, v13, s[38:39]
L_wq_nopf:
    s_mul_i32 s69, s42, 589824
    s_lshl_b32 s70, s41, 10
    s_add_u32 s69, s69, s70
    s_lshl_b32 s70, s40, 8
    s_add_u32 s69, s69, s70
    v_lshlrev_b32 v5, 13, v2
    v_lshl_add_u32 v5, v1, 4, v5
    s_waitcnt lgkmcnt(0)
    s_mov_b32 s52, s14
    s_mov_b32 s53, s15
    s_mov_b32 s54, 4718592
    s_mov_b32 s55, 0x20000
    s_load_dword s43, s[36:37], 0
    s_mov_b32 s60, s36
    s_mov_b32 s61, s37
    s_mov_b32 s62, 3145728
    s_mov_b32 s63, 0x20000
    s_barrier
    s_cmp_lt_u32 s42, 8
    s_cbranch_scc0 L_wq_none
    buffer_load_dwordx4 v[16:19], v5, s[52:55], s69 offen nt
    s_add_u32 s69, s69, 32768
    buffer_load_dwordx4 v[20:23], v5, s[52:55], s69 offen nt
    s_add_u32 s69, s69, 32768
    buffer_load_dwordx4 v[24:27], v5, s[52:55], s69 offen nt
    s_add_u32 s69, s69, 32768
    buffer_load_dwordx4 v[28:31], v5, s[52:55], s69 offen nt
    s_add_u32 s69, s69, 32768
    buffer_load_dwordx4 v[32:35], v5, s[52:55], s69 offen nt
    s_add_u32 s69, s69, 32768
    s_branch L_wq1
L_a:
    s_cmp_ge_u32 s40, 4
    s_cbranch_scc1 L_mlpw
    s_lshl_b32 s46, s42, 2
    s_add_u32 s46, s46, s40
    s_sub_u32 s46, s46, 36
    s_min_u32 s69, s46, 8
    s_mul_i32 s3, s46, 11
    s_add_u32 s3, s3, s69
    s_max_u32 s69, s46, 44
    s_min_u32 s69, s69, 52
    s_sub_u32 s3, s3, s69
    s_max_i32 s69, s46, 0x50
    s_add_u32 s3, s3, s69
    s_lshl_b32 s38, s3, 11
    s_lshl_b32 s69, s41, 24
    s_add_u32 s38, s38, s69
    s_cmp_ge_u32 s46, 46
    s_cselect_b32 s47, 1, 0
    s_add_u32 s69, s47, 1
    s_mul_i32 s69, s69, 7340032
    s_add_u32 s38, s38, s69
    s_sub_u32 s38, s38, 73728
    v_lshrrev_b32 v3, 1, v1
    v_lshlrev_b32 v3, 8, v3
    v_and_b32 v4, 1, v1
    v_lshl_add_u32 v3, v4, 6, v3
    v_lshl_add_u32 v3, v2, 4, v3
    s_movk_i32 s70, 0x1000
    s_waitcnt lgkmcnt(0)
    s_add_u32 s48, s10, s38
    s_addc_u32 s49, s11, 0
    s_mov_b32 s50, 24576
    s_mov_b32 s51, 0x20000
    buffer_load_dwordx4 v[8:11], v3, s[48:51], 0 offen offset:0 nt
    buffer_load_dwordx4 v[12:15], v3, s[48:51], 0 offen offset:128 nt
    buffer_load_dwordx4 v[16:19], v3, s[48:51], 0 offen offset:2048 nt
    buffer_load_dwordx4 v[20:23], v3, s[48:51], 0 offen offset:2176 nt
    buffer_load_dwordx4 v[24:27], v3, s[48:51], s70 offen offset:0 nt
L_att1:
    s_setprio 2
    s_add_u32 s45, s46, 1
    s_min_u32 s69, s45, 8
    s_mul_i32 s39, s45, 11
    s_add_u32 s39, s39, s69
    s_max_u32 s69, s45, 44
    s_min_u32 s69, s69, 52
    s_sub_u32 s39, s39, s69
    s_max_i32 s69, s45, 0x50
    s_add_u32 s39, s39, s69
    s_sub_u32 s3, s39, s3
    s_lshl_b32 s39, s3, 11
    s_sub_u32 s45, s42, 9
    s_lshl_b32 s46, s41, 1
    s_add_u32 s46, s46, s47
    s_movk_i32 s71, 0x2000
    s_movk_i32 s72, 0x3000
    s_movk_i32 s73, 0x4000
    s_movk_i32 s74, 0x5000
    v_mul_u32_u24 v4, 6144, v2
    v_lshl_add_u32 v4, v1, 4, v4
    s_and_b32 s69, s40, 2
    s_lshl_b32 s69, s69, 1
    s_add_u32 s69, s69, 96
    v_mov_b32 v5, s69
    s_barrier
    s_waitcnt vmcnt(4)
    buffer_load_dwordx4 v[28:31], v3, s[48:51], s70 offen offset:128 nt
    s_add_u32 s52, s12, s38
    s_addc_u32 s53, s13, 0
    s_mov_b32 s54, s39
    s_mov_b32 s55, 0x20000
    s_load_dword s43, s[36:37], 0
    s_mov_b32 s60, s36
    s_mov_b32 s61, s37
    s_mov_b32 s62, 3145728
    s_mov_b32 s63, 0x20000
    s_mov_b32 s56, s8
    s_mov_b32 s57, s9
    s_mov_b32 s58, 1152
    s_mov_b32 s59, 0x20000
    s_waitcnt vmcnt(4)
    buffer_load_dwordx4 v[32:35], v3, s[48:51], s70 offen offset:2048 nt
    s_waitcnt vmcnt(4)
    buffer_load_dwordx4 v[36:39], v3, s[48:51], s70 offen offset:2176 nt
    s_waitcnt vmcnt(4)
    buffer_load_dwordx4 v[40:43], v3, s[48:51], s71 offen offset:0 nt
    s_waitcnt vmcnt(4)
    buffer_load_dwordx4 v[44:47], v3, s[48:51], s71 offen offset:128 nt
    s_waitcnt vmcnt(4)
    buffer_load_dwordx4 v[48:51], v3, s[48:51], s71 offen offset:2048 nt
    s_waitcnt vmcnt(4)
    buffer_load_dwordx4 v[52:55], v3, s[48:51], s71 offen offset:2176 nt
    s_waitcnt vmcnt(4)
    buffer_load_dwordx4 v[56:59], v3, s[48:51], s72 offen offset:0 nt
    s_waitcnt vmcnt(4)
    buffer_load_dwordx4 v[60:63], v3, s[48:51], s72 offen offset:128 nt
    s_waitcnt lgkmcnt(0)
    s_add_u32 s43, s43, 0x01010101
    s_mov_b32 s4, 0x07060500
    s_bfe_u32 s92, s43, 0x80000
    s_mov_b32 s5, 0x07060501
    s_bfe_u32 s93, s43, 0x80008
    s_mov_b32 s6, 0x07060502
    s_bfe_u32 s94, s43, 0x80010
    s_mov_b32 s7, 0x07060503
    s_bfe_u32 s95, s43, 0x80018
    v_mov_b32 v7, s43
    v_bfe_u32 v200, v0, 3, 1
    v_mul_u32_u24 v200, 0x202, v200
    v_add_u32 v200, 0x100, v200
    v_and_b32 v201, 1, v0
    v_lshlrev_b32 v201, 4, v201
    v_lshlrev_b32 v200, v201, v200
    v_mov_b32 v202, 0x0c0c0000
    v_lshrrev_b32 v201, v201, v202
    v_or_b32 v200, v200, v201
    v_bfe_u32 v201, v0, 1, 2
    v_mov_b32 v202, 0x0c0c0c0c
    v_cmp_eq_u32 vcc, 0, v201
    s_nop 1
    v_cndmask_b32 v240, v202, v200, vcc
    v_cmp_eq_u32 vcc, 1, v201
    s_nop 1
    v_cndmask_b32 v241, v202, v200, vcc
    v_cmp_eq_u32 vcc, 2, v201
    s_nop 1
    v_cndmask_b32 v242, v202, v200, vcc
    v_cmp_eq_u32 vcc, 3, v201
    s_nop 1
    v_cndmask_b32 v243, v202, v200, vcc
    v_mov_b32 v6, 1
    v_mov_b32 v200, 104
    ds_max_u32 v200, v6
    s_waitcnt vmcnt(4)
    buffer_load_dwordx4 v[64:67], v3, s[48:51], s72 offen offset:2048 nt
    s_waitcnt vmcnt(4)
    buffer_load_dwordx4 v[68:71], v3, s[48:51], s72 offen offset:2176 nt
    v_mov_b32 v6, 2
    v_mov_b32 v200, 104
    ds_max_u32 v200, v6
    s_waitcnt vmcnt(4)
    buffer_load_dwordx4 v[72:75], v3, s[48:51], s73 offen offset:0 nt
    s_waitcnt vmcnt(4)
    buffer_load_dwordx4 v[76:79], v3, s[48:51], s73 offen offset:128 nt
    s_waitcnt vmcnt(4)
    buffer_load_dwordx4 v[80:83], v3, s[48:51], s73 offen offset:2048 nt
    s_waitcnt vmcnt(4)
    buffer_load_dwordx4 v[84:87], v3, s[48:51], s73 offen offset:2176 nt
    s_cmp_gt_u32 s3, 10
    s_cbranch_scc0 L_att_k11
    s_waitcnt vmcnt(4)
    buffer_load_dwordx4 v[88:91], v3, s[48:51], s74 offen offset:0 nt
    s_waitcnt vmcnt(4)
    buffer_load_dwordx4 v[92:95], v3, s[48:51], s74 offen offset:128 nt
    s_cmp_gt_u32 s3, 11
    s_cbranch_scc0 L_att_k11
    s_waitcnt vmcnt(4)
    buffer_load_dwordx4 v[96:99], v3, s[48:51], s74 offen offset:2048 nt
    s_waitcnt vmcnt(4)
    buffer_load_dwordx4 v[100:103], v3, s[48:51], s74 offen offset:2176 nt
L_att_k11:
    s_waitcnt vmcnt(6)
    buffer_load_dwordx4 v[104:107], v4, s[52:55], 0 offen offset:0 nt
    s_waitcnt vmcnt(6)
    buffer_load_dwordx4 v[108:111], v4, s[52:55], 0 offen offset:256 nt
    s_waitcnt vmcnt(6)
    buffer_load_dwordx4 v[112:115], v4, s[52:55], 0 offen offset:512 nt
    s_and_b32 s38, s40, 2
    s_lshl_b32 s38, s38, 8
    s_add_u32 s38, s38, 128
    v_bfe_u32 v3, v0, 1, 1
    v_lshlrev_b32 v3, 8, v3
    v_and_b32 v6, 1, v0
    v_lshl_add_u32 v3, v6, 6, v3
    v_lshl_add_u32 v3, v2, 4, v3
    v_add_u32 v3, s38, v3
    v_lshrrev_b32 v6, 2, v1
    v_mov_b32 v200, 19712
    v_cmp_eq_u32 vcc, 0, v6
    s_nop 1
    v_cndmask_b32 v244, v200, v3, vcc
    v_cmp_eq_u32 vcc, 1, v6
    s_nop 1
    v_cndmask_b32 v245, v200, v3, vcc
    v_cmp_eq_u32 vcc, 2, v6
    s_nop 1
    v_cndmask_b32 v246, v200, v3, vcc
    v_cmp_eq_u32 vcc, 3, v6
    s_nop 1
    v_cndmask_b32 v247, v200, v3, vcc
    s_waitcnt vmcnt(6)
    buffer_load_dwordx4 v[116:119], v4, s[52:55], 0 offen offset:768 nt
    s_waitcnt vmcnt(6)
    buffer_load_dwordx4 v[120:123], v4, s[52:55], 0 offen offset:1024 nt
    s_cmp_eq_u32 s45, 11
    s_cselect_b32 s72, 2, 4
    s_and_b32 s73, s40, 2
    s_cmp_eq_u32 s45, 11
    s_cselect_b32 s73, s73, 0
    s_add_u32 s38, s73, 0
    s_lshl_b32 s8, s38, 10
    s_add_u32 s8, s8, 2176
    s_lshl_b32 s38, s38, 4
    s_add_u32 s12, s38, 32
    s_add_u32 s38, s73, 1
    s_lshl_b32 s9, s38, 10
    s_add_u32 s9, s9, 2176
    s_lshl_b32 s38, s38, 4
    s_add_u32 s13, s38, 32
    s_add_u32 s38, s73, 2
    s_lshl_b32 s10, s38, 10
    s_add_u32 s10, s10, 2176
    s_lshl_b32 s38, s38, 4
    s_add_u32 s14, s38, 32
    s_cmp_eq_u32 s72, 2
    s_cselect_b32 s10, 19712, s10
    s_cselect_b32 s14, 16, s14
    s_add_u32 s38, s73, 3
    s_lshl_b32 s11, s38, 10
    s_add_u32 s11, s11, 2176
    s_lshl_b32 s38, s38, 4
    s_add_u32 s15, s38, 32
    s_cmp_eq_u32 s72, 2
    s_cselect_b32 s11, 19712, s11
    s_cselect_b32 s15, 16, s15
    s_lshl_b32 s16, s40, 4
    s_add_u32 s16, s16, 32
    s_lshl_b32 s17, s40, 10
    s_add_u32 s17, s17, 2176
    s_lshl_b32 s18, s73, 1
    s_mul_i32 s38, s47, 11
    s_sub_u32 s38, s45, s38
    s_mul_i32 s39, s46, 12
    s_add_u32 s38, s38, s39
    s_mul_i32 s74, s38, 1152
    s_add_u32 s74, s74, 112640
    s_sub_u32 s19, s3, 2
    s_sub_u32 s20, s3, 1
    s_mov_b32 s78, 0xaaaaaaaa
    s_mov_b32 s79, 0xaaaaaaaa
    v_mul_u32_u24 v3, 3, v2
    s_waitcnt vmcnt(6)
    buffer_load_dwordx4 v[124:127], v4, s[52:55], 0 offen offset:1280 nt
    s_mov_b32 s21, 0
    s_waitcnt vmcnt(6)
    buffer_load_dwordx4 v[128:131], v4, s[52:55], 0 offen offset:1536 nt
    s_waitcnt vmcnt(6)
    buffer_load_dwordx4 v[132:135], v4, s[52:55], 0 offen offset:1792 nt
    ds_read_b32 v6, v5
    s_waitcnt lgkmcnt(0)
    v_cmp_ne_u32 vcc, 0, v6
    s_cbranch_vccnz L_bur_8
    s_waitcnt vmcnt(6)
    buffer_load_dwordx4 v[136:139], v4, s[52:55], 0 offen offset:2048 nt
    ds_read_b32 v6, v5
    s_waitcnt lgkmcnt(0)
    v_cmp_ne_u32 vcc, 0, v6
    s_cbranch_vccnz L_bur_9
    s_waitcnt vmcnt(6)
    buffer_load_dwordx4 v[140:143], v4, s[52:55], 0 offen offset:2304 nt
    ds_read_b32 v6, v5
    s_waitcnt lgkmcnt(0)
    v_cmp_ne_u32 vcc, 0, v6
    s_cbranch_vccnz L_bur_10
    s_waitcnt vmcnt(6)
    buffer_load_dwordx4 v[144:147], v4, s[52:55], 0 offen offset:2560 nt
    ds_read_b32 v6, v5
    s_waitcnt lgkmcnt(0)
    v_cmp_ne_u32 vcc, 0, v6
    s_cbranch_vccnz L_bur_11
    s_waitcnt vmcnt(6)
    buffer_load_dwordx4 v[148:151], v4, s[52:55], 0 offen offset:2816 nt
    ds_read_b32 v6, v5
    s_waitcnt lgkmcnt(0)
    v_cmp_ne_u32 vcc, 0, v6
    s_cbranch_vccnz L_bur_12
    s_waitcnt vmcnt(6)
    buffer_load_dwordx4 v[152:155], v4, s[52:55], 0 offen offset:3072 nt
    ds_read_b32 v6, v5
    s_waitcnt lgkmcnt(0)
    v_cmp_ne_u32 vcc, 0, v6
    s_cbranch_vccnz L_bur_13
    s_waitcnt vmcnt(6)
    buffer_load_dwordx4 v[156:159], v4, s[52:55], 0 offen offset:3328 nt
    ds_read_b32 v6, v5
    s_waitcnt lgkmcnt(0)
    v_cmp_ne_u32 vcc, 0, v6
    s_cbranch_vccnz L_bur_14
    s_waitcnt vmcnt(6)
    buffer_load_dwordx4 v[160:163], v4, s[52:55], 0 offen offset:3584 nt
    ds_read_b32 v6, v5
    s_waitcnt lgkmcnt(0)
    v_cmp_ne_u32 vcc, 0, v6
    s_cbranch_vccnz L_bur_15
    s_waitcnt vmcnt(6)
    buffer_load_dwordx4 v[164:167], v4, s[52:55], 0 offen offset:3840 nt
    ds_read_b32 v6, v5
    s_waitcnt lgkmcnt(0)
    v_cmp_ne_u32 vcc, 0, v6
    s_cbranch_vccnz L_bur_16
    s_waitcnt vmcnt(6)
    buffer_load_dwordx4 v[168:171], v4, s[52:55], s70 offen offset:0 nt
    s_mov_b32 s68, 0
L_q_wait:
    ds_read_b32 v6, v5
    s_waitcnt lgkmcnt(0)
    v_cmp_ne_u32 vcc, 0, v6
    s_cbranch_vccnz L_bur_17
    s_add_u32 s68, s68, 1
    s_cmp_lt_u32 s68, 640000
    s_cbranch_scc1 L_q_wait
    s_branch L_bur_17
L_bur_8:
    buffer_load_dwordx4 v[136:139], v4, s[52:55], 0 offen offset:2048 nt
L_bur_9:
    buffer_load_dwordx4 v[140:143], v4, s[52:55], 0 offen offset:2304 nt
L_bur_10:
    buffer_load_dwordx4 v[144:147], v4, s[52:55], 0 offen offset:2560 nt
L_bur_11:
    buffer_load_dwordx4 v[148:151], v4, s[52:55], 0 offen offset:2816 nt
L_bur_12:
    buffer_load_dwordx4 v[152:155], v4, s[52:55], 0 offen offset:3072 nt
L_bur_13:
    buffer_load_dwordx4 v[156:159], v4, s[52:55], 0 offen offset:3328 nt
L_bur_14:
    buffer_load_dwordx4 v[160:163], v4, s[52:55], 0 offen offset:3584 nt
L_bur_15:
    buffer_load_dwordx4 v[164:167], v4, s[52:55], 0 offen offset:3840 nt
L_bur_16:
    buffer_load_dwordx4 v[168:171], v4, s[52:55], s70 offen offset:0 nt
L_bur_17:
    buffer_load_dwordx4 v[172:175], v4, s[52:55], s70 offen offset:256 nt
L_bur_18:
    buffer_load_dwordx4 v[176:179], v4, s[52:55], s70 offen offset:512 nt
L_bur_19:
    buffer_load_dwordx4 v[180:183], v4, s[52:55], s70 offen offset:768 nt
L_bur_20:
    buffer_load_dwordx4 v[184:187], v4, s[52:55], s70 offen offset:1024 nt
L_bur_21:
    buffer_load_dwordx4 v[188:191], v4, s[52:55], s70 offen offset:1280 nt
L_bur_22:
    buffer_load_dwordx4 v[192:195], v4, s[52:55], s70 offen offset:1536 nt
L_bur_23:
    buffer_load_dwordx4 v[196:199], v4, s[52:55], s70 offen offset:1792 nt
L_bur_24:
    s_cmp_eq_u32 s21, 0
    s_cbranch_scc0 L_att_lead
    v_mov_b32 v4, 108
    v_mov_b32 v5, 1
    s_mov_b64 exec, 1
    ds_add_u32 v4, v5
    s_mov_b64 exec, -1
L_att_lead:
    v_readfirstlane_b32 s76, v6
    ds_read_b128 v[208:211], v244
    ds_read_b128 v[212:215], v244 offset:128
    ds_read_b128 v[216:219], v245
    ds_read_b128 v[220:223], v245 offset:128
    ds_read_b128 v[200:203], v246
    ds_read_b128 v[204:207], v246 offset:128
    ds_read_b128 v[248:251], v247
    ds_read_b128 v[252:255], v247 offset:128
    s_waitcnt lgkmcnt(6)
    v_mfma_f32_16x16x32_bf16 v[224:227], v[208:211], v[8:11], 0
    v_mfma_f32_16x16x32_bf16 v[224:227], v[212:215], v[12:15], v[224:227]
    v_mfma_f32_16x16x32_bf16 v[228:231], v[208:211], v[16:19], 0
    v_mfma_f32_16x16x32_bf16 v[228:231], v[212:215], v[20:23], v[228:231]
    v_mfma_f32_16x16x32_bf16 v[232:235], v[208:211], v[24:27], 0
    v_mfma_f32_16x16x32_bf16 v[232:235], v[212:215], v[28:31], v[232:235]
    s_waitcnt lgkmcnt(4)
    v_mfma_f32_16x16x32_bf16 v[224:227], v[216:219], v[32:35], v[224:227]
    v_mfma_f32_16x16x32_bf16 v[224:227], v[220:223], v[36:39], v[224:227]
    v_mfma_f32_16x16x32_bf16 v[228:231], v[216:219], v[40:43], v[228:231]
    v_mfma_f32_16x16x32_bf16 v[228:231], v[220:223], v[44:47], v[228:231]
    v_mfma_f32_16x16x32_bf16 v[232:235], v[216:219], v[48:51], v[232:235]
    v_mfma_f32_16x16x32_bf16 v[232:235], v[220:223], v[52:55], v[232:235]
    s_waitcnt lgkmcnt(2)
    v_mfma_f32_16x16x32_bf16 v[224:227], v[200:203], v[56:59], v[224:227]
    v_mfma_f32_16x16x32_bf16 v[224:227], v[204:207], v[60:63], v[224:227]
    v_mfma_f32_16x16x32_bf16 v[228:231], v[200:203], v[64:67], v[228:231]
    v_mfma_f32_16x16x32_bf16 v[228:231], v[204:207], v[68:71], v[228:231]
    v_mfma_f32_16x16x32_bf16 v[232:235], v[200:203], v[72:75], v[232:235]
    v_mfma_f32_16x16x32_bf16 v[232:235], v[204:207], v[76:79], v[232:235]
    s_waitcnt lgkmcnt(0)
    v_mfma_f32_16x16x32_bf16 v[224:227], v[248:251], v[80:83], v[224:227]
    v_mfma_f32_16x16x32_bf16 v[224:227], v[252:255], v[84:87], v[224:227]
    s_cmp_gt_u32 s3, 10
    s_cbranch_scc0 L_att_m11
    v_mfma_f32_16x16x32_bf16 v[228:231], v[248:251], v[88:91], v[228:231]
    v_mfma_f32_16x16x32_bf16 v[228:231], v[252:255], v[92:95], v[228:231]
    s_cmp_gt_u32 s3, 11
    s_cbranch_scc0 L_att_m11
    v_mfma_f32_16x16x32_bf16 v[232:235], v[248:251], v[96:99], v[232:235]
    v_mfma_f32_16x16x32_bf16 v[232:235], v[252:255], v[100:103], v[232:235]
L_att_m11:
    v_lshlrev_b32 v19, 4, v0
    v_add_u32 v20, s17, v19
    v_add_u32 v24, s8, v19
    v_add_u32 v25, s9, v19
    v_add_u32 v26, s10, v19
    v_add_u32 v27, s11, v19
    v_lshrrev_b32 v19, 5, v0
    v_lshlrev_b32 v33, 6, v19
    v_lshlrev_b32 v32, 9, v19
    v_lshlrev_b32 v19, 3, v19
    v_cndmask_b32 v12, v226, v225, s[78:79]
    v_cndmask_b32 v8, v224, v227, s[78:79]
    v_cndmask_b32 v13, v230, v229, s[78:79]
    v_cndmask_b32 v9, v228, v231, s[78:79]
    v_cndmask_b32 v14, v234, v233, s[78:79]
    v_cndmask_b32 v10, v232, v235, s[78:79]
    v_add_f32_dpp v8, v12, v8 quad_perm:[1,0,3,2] row_mask:0xf bank_mask:0xf
    v_add_f32_dpp v9, v13, v9 quad_perm:[1,0,3,2] row_mask:0xf bank_mask:0xf
    v_add_f32_dpp v10, v14, v10 quad_perm:[1,0,3,2] row_mask:0xf bank_mask:0xf
    v_cvt_pk_bf16_f32 v12, v8, v9
    v_lshlrev_b32 v8, 16, v12
    v_and_b32 v9, 0xffff0000, v12
    v_cvt_pk_bf16_f32 v10, v10, v10
    v_and_b32 v10, 0xffff0000, v10
    v_mul_f32 v8, 0x3db504f3, v8
    v_mul_f32 v9, 0x3db504f3, v9
    v_mul_f32 v10, 0x3db504f3, v10
    v_cvt_pk_bf16_f32 v12, v8, v9
    v_lshlrev_b32 v8, 16, v12
    v_and_b32 v9, 0xffff0000, v12
    v_cvt_pk_bf16_f32 v10, v10, v10
    v_and_b32 v10, 0xffff0000, v10
    v_cmp_gt_i32 vcc, s19, v3
    v_cmp_gt_i32 s[78:79], s20, v3
    v_mov_b32 v4, 0xff800000
    v_cndmask_b32 v10, v4, v10, vcc
    v_cndmask_b32 v9, v4, v9, s[78:79]
    v_max3_f32 v16, v8, v9, v10
    s_nop 1
    v_max_f32_dpp v16, v16, v16 quad_perm:[2,3,0,1] row_mask:0xf bank_mask:0xf
    s_nop 1
    v_max_f32_dpp v16, v16, v16 row_ror:4 row_mask:0xf bank_mask:0xf
    s_nop 1
    v_max_f32_dpp v16, v16, v16 row_ror:8 row_mask:0xf bank_mask:0xf
    v_mov_b32 v18, v16
    s_nop 1
    v_permlane16_swap_b32 v18, v16
    v_max_f32 v16, v16, v18
    v_mov_b32 v18, v16
    s_nop 1
    v_permlane32_swap_b32 v18, v16
    v_max_f32 v16, v16, v18
    v_sub_f32 v8, v8, v16
    v_sub_f32 v9, v9, v16
    v_sub_f32 v10, v10, v16
    v_mul_f32 v8, 0x3fb8aa3b, v8
    v_mul_f32 v9, 0x3fb8aa3b, v9
    v_mul_f32 v10, 0x3fb8aa3b, v10
    v_exp_f32 v8, v8
    v_exp_f32 v9, v9
    v_exp_f32 v10, v10
    v_mov_b32_dpp v12, v8 quad_perm:[1,0,3,2] row_mask:0xf bank_mask:0xf
    v_mov_b32_dpp v13, v9 quad_perm:[1,0,3,2] row_mask:0xf bank_mask:0xf
    v_mov_b32_dpp v14, v10 quad_perm:[1,0,3,2] row_mask:0xf bank_mask:0xf
    v_cvt_pk_bf16_f32 v244, v8, v12
    v_cvt_pk_bf16_f32 v245, v9, v13
    v_cvt_pk_bf16_f32 v246, v10, v14
    v_mov_b32_dpp v247, v244 row_newbcast:0 row_mask:0xf bank_mask:0xf
    v_mov_b32_dpp v6, v244 row_newbcast:2 row_mask:0xf bank_mask:0xf
    v_perm_b32 v248, v247, v247, v240
    v_perm_b32 v249, v247, v247, v241
    v_perm_b32 v250, v247, v247, v242
    v_perm_b32 v251, v247, v247, v243
    v_perm_b32 v252, v6, v6, v240
    v_perm_b32 v253, v6, v6, v241
    v_perm_b32 v254, v6, v6, v242
    v_perm_b32 v255, v6, v6, v243
    s_waitcnt vmcnt(20)
    v_mfma_f32_16x16x32_bf16 v[236:239], v[248:251], v[104:107], 0
    v_mov_b32_dpp v247, v244 row_newbcast:4 row_mask:0xf bank_mask:0xf
    v_perm_b32 v248, v247, v247, v240
    v_perm_b32 v249, v247, v247, v241
    v_perm_b32 v250, v247, v247, v242
    v_perm_b32 v251, v247, v247, v243
    v_mfma_f32_16x16x32_bf16 v[236:239], v[252:255], v[108:111], v[236:239]
    v_mov_b32_dpp v6, v244 row_newbcast:6 row_mask:0xf bank_mask:0xf
    v_perm_b32 v252, v6, v6, v240
    v_perm_b32 v253, v6, v6, v241
    v_perm_b32 v254, v6, v6, v242
    v_perm_b32 v255, v6, v6, v243
    v_mfma_f32_16x16x32_bf16 v[236:239], v[248:251], v[112:115], v[236:239]
    v_mov_b32_dpp v247, v244 row_newbcast:8 row_mask:0xf bank_mask:0xf
    v_add_f32 v17, v8, v9
    v_add_f32 v17, v17, v10
    v_and_b32 v21, 1, v0
    v_lshl_add_u32 v21, v21, 3, s16
    v_mov_b32 v22, s18
    v_mov_b32 v23, 1
    v_add_f32_dpp v17, v17, v17 quad_perm:[2,3,0,1] row_mask:0xf bank_mask:0xf
    s_nop 1
    v_add_f32_dpp v17, v17, v17 row_ror:4 row_mask:0xf bank_mask:0xf
    s_nop 1
    v_add_f32_dpp v17, v17, v17 row_ror:8 row_mask:0xf bank_mask:0xf
    v_mov_b32 v18, v17
    s_nop 1
    v_permlane16_swap_b32 v18, v17
    v_add_f32 v17, v17, v18
    v_mov_b32 v18, v17
    s_nop 1
    v_permlane32_swap_b32 v18, v17
    v_add_f32 v17, v17, v18
    s_mov_b64 exec, 3
    ds_write_b64 v21, v[16:17]
    s_mov_b64 exec, 1
    ds_add_u32 v22, v23 offset:8
    s_mov_b64 exec, -1
    v_add_u32 v21, s16, v19
    v_add_u32 v28, s12, v19
    v_add_u32 v29, s13, v19
    v_add_u32 v30, s14, v19
    v_add_u32 v31, s15, v19
    v_lshl_add_u32 v32, v1, 5, v32
    v_and_b32 v34, 1, v2
    v_lshl_add_u32 v32, v34, 4, v32
    v_and_b32 v34, 3, v0
    v_lshl_add_u32 v33, v34, 4, v33
    v_perm_b32 v248, v247, v247, v240
    v_perm_b32 v249, v247, v247, v241
    v_perm_b32 v250, v247, v247, v242
    v_perm_b32 v251, v247, v247, v243
    v_mfma_f32_16x16x32_bf16 v[236:239], v[252:255], v[116:119], v[236:239]
    v_mov_b32_dpp v6, v244 row_newbcast:10 row_mask:0xf bank_mask:0xf
    v_perm_b32 v252, v6, v6, v240
    v_perm_b32 v253, v6, v6, v241
    v_perm_b32 v254, v6, v6, v242
    v_perm_b32 v255, v6, v6, v243
    s_waitcnt vmcnt(16)
    v_mfma_f32_16x16x32_bf16 v[236:239], v[248:251], v[120:123], v[236:239]
    v_mov_b32_dpp v247, v244 row_newbcast:12 row_mask:0xf bank_mask:0xf
    v_perm_b32 v248, v247, v247, v240
    v_perm_b32 v249, v247, v247, v241
    v_perm_b32 v250, v247, v247, v242
    v_perm_b32 v251, v247, v247, v243
    v_mfma_f32_16x16x32_bf16 v[236:239], v[252:255], v[124:127], v[236:239]
    v_mov_b32_dpp v6, v244 row_newbcast:14 row_mask:0xf bank_mask:0xf
    v_perm_b32 v252, v6, v6, v240
    v_perm_b32 v253, v6, v6, v241
    v_perm_b32 v254, v6, v6, v242
    v_perm_b32 v255, v6, v6, v243
    v_mfma_f32_16x16x32_bf16 v[236:239], v[248:251], v[128:131], v[236:239]
    v_mov_b32_dpp v247, v245 row_newbcast:0 row_mask:0xf bank_mask:0xf
    v_perm_b32 v248, v247, v247, v240
    v_perm_b32 v249, v247, v247, v241
    v_perm_b32 v250, v247, v247, v242
    v_perm_b32 v251, v247, v247, v243
    v_mfma_f32_16x16x32_bf16 v[236:239], v[252:255], v[132:135], v[236:239]
    v_mov_b32_dpp v6, v245 row_newbcast:2 row_mask:0xf bank_mask:0xf
    v_perm_b32 v252, v6, v6, v240
    v_perm_b32 v253, v6, v6, v241
    v_perm_b32 v254, v6, v6, v242
    v_perm_b32 v255, v6, v6, v243
    s_waitcnt vmcnt(12)
    v_mfma_f32_16x16x32_bf16 v[236:239], v[248:251], v[136:139], v[236:239]
    v_mov_b32_dpp v247, v245 row_newbcast:4 row_mask:0xf bank_mask:0xf
    v_perm_b32 v248, v247, v247, v240
    v_perm_b32 v249, v247, v247, v241
    v_perm_b32 v250, v247, v247, v242
    v_perm_b32 v251, v247, v247, v243
    v_mfma_f32_16x16x32_bf16 v[236:239], v[252:255], v[140:143], v[236:239]
    v_mov_b32_dpp v6, v245 row_newbcast:6 row_mask:0xf bank_mask:0xf
    v_perm_b32 v252, v6, v6, v240
    v_perm_b32 v253, v6, v6, v241
    v_perm_b32 v254, v6, v6, v242
    v_perm_b32 v255, v6, v6, v243
    v_mfma_f32_16x16x32_bf16 v[236:239], v[248:251], v[144:147], v[236:239]
    v_mov_b32_dpp v247, v245 row_newbcast:8 row_mask:0xf bank_mask:0xf
    v_perm_b32 v248, v247, v247, v240
    v_perm_b32 v249, v247, v247, v241
    v_perm_b32 v250, v247, v247, v242
    v_perm_b32 v251, v247, v247, v243
    v_mfma_f32_16x16x32_bf16 v[236:239], v[252:255], v[148:151], v[236:239]
    v_mov_b32_dpp v6, v245 row_newbcast:10 row_mask:0xf bank_mask:0xf
    v_mov_b32 v72, 112
    v_mov_b32 v73, 1
    ds_max_u32 v72, v73
    v_perm_b32 v252, v6, v6, v240
    v_perm_b32 v253, v6, v6, v241
    v_perm_b32 v254, v6, v6, v242
    v_perm_b32 v255, v6, v6, v243
    s_waitcnt vmcnt(8)
    v_mfma_f32_16x16x32_bf16 v[236:239], v[248:251], v[152:155], v[236:239]
    v_mov_b32_dpp v247, v245 row_newbcast:12 row_mask:0xf bank_mask:0xf
    v_perm_b32 v248, v247, v247, v240
    v_perm_b32 v249, v247, v247, v241
    v_perm_b32 v250, v247, v247, v242
    v_perm_b32 v251, v247, v247, v243
    v_mfma_f32_16x16x32_bf16 v[236:239], v[252:255], v[156:159], v[236:239]
    v_mov_b32_dpp v6, v245 row_newbcast:14 row_mask:0xf bank_mask:0xf
    s_mov_b32 s68, 0
L_st_loop:
    ds_read_b32 v72, v22 offset:8
    ds_read_b64 v[74:75], v28
    ds_read_b64 v[76:77], v29
    ds_read_b64 v[78:79], v30
    ds_read_b64 v[80:81], v31
    ds_read_b32 v82, v21
    s_waitcnt lgkmcnt(0)
    v_cmp_ne_u32 vcc, s72, v72
    s_cbranch_vccnz L_st_retry
L_st_ok:
    v_max3_f32 v84, v74, v76, v78
    v_max_f32 v84, v84, v80
    v_sub_f32 v74, v74, v84
    v_sub_f32 v76, v76, v84
    v_sub_f32 v78, v78, v84
    v_sub_f32 v80, v80, v84
    v_sub_f32 v82, v82, v84
    v_mul_f32 v74, 0x3fb8aa3b, v74
    v_mul_f32 v76, 0x3fb8aa3b, v76
    v_mul_f32 v78, 0x3fb8aa3b, v78
    v_mul_f32 v80, 0x3fb8aa3b, v80
    v_mul_f32 v82, 0x3fb8aa3b, v82
    v_exp_f32 v74, v74
    v_exp_f32 v76, v76
    v_exp_f32 v78, v78
    v_exp_f32 v80, v80
    v_exp_f32 v35, v82
    v_mul_f32 v85, v74, v75
    v_fmac_f32 v85, v76, v77
    v_fmac_f32 v85, v78, v79
    v_fmac_f32 v85, v80, v81
    v_mov_b32 v86, v84
    v_mov_b32 v87, v85
    v_perm_b32 v84, v84, v7, s4
    v_perm_b32 v85, v85, v7, s5
    v_perm_b32 v86, v86, v7, s6
    v_perm_b32 v87, v87, v7, s7
    s_mov_b32 s78, 15
    s_mov_b32 s79, 15
    s_mov_b64 exec, s[78:79]
    s_cmp_eq_u32 s76, 2
    s_cbranch_scc0 L_st_slow
    buffer_store_dwordx4 v[84:87], v33, s[60:63], s74 offen offset:1024
L_st_done:
    s_mov_b64 exec, -1
    s_sub_u32 s72, s72, 1
    v_perm_b32 v252, v6, v6, v240
    v_perm_b32 v253, v6, v6, v241
    v_perm_b32 v254, v6, v6, v242
    v_perm_b32 v255, v6, v6, v243
    v_mfma_f32_16x16x32_bf16 v[236:239], v[248:251], v[160:163], v[236:239]
    v_mov_b32_dpp v247, v246 row_newbcast:0 row_mask:0xf bank_mask:0xf
    v_perm_b32 v248, v247, v247, v240
    v_perm_b32 v249, v247, v247, v241
    v_perm_b32 v250, v247, v247, v242
    v_perm_b32 v251, v247, v247, v243
    v_mfma_f32_16x16x32_bf16 v[236:239], v[252:255], v[164:167], v[236:239]
    v_mov_b32_dpp v6, v246 row_newbcast:2 row_mask:0xf bank_mask:0xf
    v_perm_b32 v252, v6, v6, v240
    v_perm_b32 v253, v6, v6, v241
    v_perm_b32 v254, v6, v6, v242
    v_perm_b32 v255, v6, v6, v243
    s_waitcnt vmcnt(8)
    v_mfma_f32_16x16x32_bf16 v[236:239], v[248:251], v[168:171], v[236:239]
    v_mov_b32_dpp v247, v246 row_newbcast:4 row_mask:0xf bank_mask:0xf
    v_perm_b32 v248, v247, v247, v240
    v_perm_b32 v249, v247, v247, v241
    v_perm_b32 v250, v247, v247, v242
    v_perm_b32 v251, v247, v247, v243
    s_waitcnt vmcnt(7)
    v_mfma_f32_16x16x32_bf16 v[236:239], v[252:255], v[172:175], v[236:239]
    v_mov_b32_dpp v6, v246 row_newbcast:6 row_mask:0xf bank_mask:0xf
    v_perm_b32 v252, v6, v6, v240
    v_perm_b32 v253, v6, v6, v241
    v_perm_b32 v254, v6, v6, v242
    v_perm_b32 v255, v6, v6, v243
    s_waitcnt vmcnt(6)
    v_mfma_f32_16x16x32_bf16 v[236:239], v[248:251], v[176:179], v[236:239]
    v_mov_b32_dpp v247, v246 row_newbcast:8 row_mask:0xf bank_mask:0xf
    v_perm_b32 v248, v247, v247, v240
    v_perm_b32 v249, v247, v247, v241
    v_perm_b32 v250, v247, v247, v242
    v_perm_b32 v251, v247, v247, v243
    s_waitcnt vmcnt(5)
    v_mfma_f32_16x16x32_bf16 v[236:239], v[252:255], v[180:183], v[236:239]
    v_mov_b32_dpp v6, v246 row_newbcast:10 row_mask:0xf bank_mask:0xf
    v_perm_b32 v252, v6, v6, v240
    v_perm_b32 v253, v6, v6, v241
    v_perm_b32 v254, v6, v6, v242
    v_perm_b32 v255, v6, v6, v243
    s_waitcnt vmcnt(4)
    v_mfma_f32_16x16x32_bf16 v[236:239], v[248:251], v[184:187], v[236:239]
    v_mov_b32_dpp v247, v246 row_newbcast:12 row_mask:0xf bank_mask:0xf
    v_perm_b32 v248, v247, v247, v240
    v_perm_b32 v249, v247, v247, v241
    v_perm_b32 v250, v247, v247, v242
    v_perm_b32 v251, v247, v247, v243
    s_waitcnt vmcnt(3)
    v_mfma_f32_16x16x32_bf16 v[236:239], v[252:255], v[188:191], v[236:239]
    v_mov_b32_dpp v6, v246 row_newbcast:14 row_mask:0xf bank_mask:0xf
    v_perm_b32 v252, v6, v6, v240
    v_perm_b32 v253, v6, v6, v241
    v_perm_b32 v254, v6, v6, v242
    v_perm_b32 v255, v6, v6, v243
    s_waitcnt vmcnt(2)
    v_mfma_f32_16x16x32_bf16 v[236:239], v[248:251], v[192:195], v[236:239]
    s_waitcnt vmcnt(1)
    v_mfma_f32_16x16x32_bf16 v[236:239], v[252:255], v[196:199], v[236:239]
    s_nop 7
    v_mul_f32 v236, v35, v236
    v_mul_f32 v237, v35, v237
    v_mul_f32 v238, v35, v238
    v_mul_f32 v239, v35, v239
    ds_write_b128 v20, v[236:239]
    s_mov_b64 exec, 1
    ds_add_rtn_u32 v23, v22, v23
    s_mov_b64 exec, -1
    ds_read_b128 v[72:75], v24
    ds_read_b128 v[76:79], v25
    ds_read_b128 v[80:83], v26
    ds_read_b128 v[84:87], v27
    s_waitcnt lgkmcnt(4)
    v_readfirstlane_b32 s38, v23
    s_cmp_eq_u32 s38, s72
    s_cbranch_scc0 L_att_done
    s_waitcnt lgkmcnt(2)
    v_pk_add_f32 v[72:73], v[72:73], v[76:77]
    v_pk_add_f32 v[74:75], v[74:75], v[78:79]
    s_waitcnt lgkmcnt(0)
    v_pk_add_f32 v[80:81], v[80:81], v[84:85]
    v_pk_add_f32 v[82:83], v[82:83], v[86:87]
    v_pk_add_f32 v[72:73], v[72:73], v[80:81]
    v_pk_add_f32 v[74:75], v[74:75], v[82:83]
    v_perm_b32 v72, v72, v7, s4
    v_perm_b32 v73, v73, v7, s5
    v_perm_b32 v74, v74, v7, s6
    v_perm_b32 v75, v75, v7, s7
    s_cmp_eq_u32 s76, 2
    s_cbranch_scc0 L_att_slow
    buffer_store_dwordx4 v[72:75], v32, s[60:63], s74 offen
L_att_pub:
    v_mov_b32 v76, 112
    ds_write_b32 v76, v76
L_att_done:
    s_waitcnt lgkmcnt(0)
    s_sub_u32 s38, s45, 2
    s_cmp_lt_u32 s38, 18
    s_cbranch_scc0 L_att_exit
    s_lshl_b32 s77, s40, 8
    v_mul_u32_u24 v54, 13824, v2
    v_lshl_add_u32 v54, v1, 4, v54
    v_add_u32 v54, s77, v54
    v_lshlrev_b32 v55, 3, v1
    v_lshl_add_u32 v55, v2, 1, v55
    s_lshr_b32 s38, s77, 1
    v_add_u32 v55, s38, v55
    s_mov_b32 s38, 8704
    s_mov_b32 s39, 13312
    buffer_load_dwordx4 v[40:43], v54, s[60:63], s38 offen sc1
    buffer_load_dwordx4 v[44:47], v54, s[60:63], s38 offen offset:2304 sc1
    buffer_load_dwordx4 v[48:51], v54, s[60:63], s39 offen sc1
    buffer_load_ushort v52, v55, s[56:59], 0 offen
    s_waitcnt vmcnt(0)
    s_branch L_s4
L_att_exit:
    s_endpgm
L_mlpw:
    s_sub_u32 s45, s42, 9
    s_sub_u32 s46, s40, 4
    s_mov_b32 s44, 0
    s_cmp_lt_u32 s46, 2
    s_cbranch_scc1 L_mlpw_go
    s_sub_u32 s38, s45, 2
    s_cmp_lt_u32 s38, 18
    s_cbranch_scc0 L_end
    s_cmp_eq_u32 s46, 2
    s_cbranch_scc1 L_tile_a
L_mlpw_go:
    s_cmp_eq_u32 s46, 0
    s_cbranch_scc0 L_mlpw_noinit
    v_mov_b32 v3, 0
    v_mov_b32 v8, 0
    v_mov_b32 v9, 0
    v_mov_b32 v10, 0
    v_mov_b32 v11, 0
    v_lshlrev_b32 v6, 4, v0
    v_mov_b32 v12, 0xff800000
    v_mov_b32 v13, 0
    v_mov_b32 v14, 0xff800000
    v_mov_b32 v15, 0
    ds_write_b128 v3, v[8:11] offset:0
    ds_write_b128 v3, v[12:15] offset:16
    ds_write_b128 v6, v[8:11] offset:19712
    ds_write_b128 v3, v[8:11] offset:96
    ds_write_b128 v3, v[8:11] offset:112
L_mlpw_noinit:
    s_mul_i32 s38, s46, 384
    s_add_u32 s38, s38, 6272
    s_lshl_b32 s38, s46, 8
    s_add_u32 s38, s38, 7808
    v_lshlrev_b32 v4, 5, v1
    v_lshl_add_u32 v226, v2, 4, v4
    v_add_u32 v253, s38, v226
    s_and_b32 s77, s45, 1
    v_and_b32 v4, 31, v0
    v_lshlrev_b32 v4, 2, v4
    v_lshrrev_b32 v5, 5, v0
    v_lshl_add_u32 v227, v5, 8, v4
    v_lshl_add_u32 v4, v5, 9, v4
    s_lshl_b32 s38, s77, 7
    s_add_u32 s38, s38, 7808
    v_add_u32 v254, s38, v4
    v_lshrrev_b32 v4, 3, v1
    v_lshl_add_u32 v4, v2, 1, v4
    v_and_b32 v5, 7, v1
    v_lshlrev_b32 v5, 4, v5
    s_cmp_eq_u32 s44, 0
    s_cbranch_scc0 L_mlpw_t
    s_waitcnt lgkmcnt(0)
    s_barrier
    s_load_dword s43, s[36:37], 0
    s_mov_b32 s60, s36
    s_mov_b32 s61, s37
    s_mov_b32 s62, 3145728
    s_mov_b32 s63, 0x20000
    s_waitcnt lgkmcnt(0)
    s_add_u32 s43, s43, 0x01010101
    s_mov_b32 s4, 0x07060500
    s_bfe_u32 s92, s43, 0x80000
    s_mov_b32 s5, 0x07060501
    s_bfe_u32 s93, s43, 0x80008
    s_mov_b32 s6, 0x07060502
    s_bfe_u32 s94, s43, 0x80010
    s_mov_b32 s7, 0x07060503
    s_bfe_u32 s95, s43, 0x80018
    v_mov_b32 v7, s43
L_mlpw_t:
    s_waitcnt lgkmcnt(0)
    v_mov_b32 v7, s43
    v_bfe_u32 v8, v0, 3, 1
    v_mul_u32_u24 v8, 0x202, v8
    v_add_u32 v8, 0x100, v8
    v_and_b32 v9, 1, v0
    v_lshlrev_b32 v9, 4, v9
    v_lshlrev_b32 v8, v9, v8
    v_mov_b32 v13, 0x0c0c0000
    v_lshrrev_b32 v9, v9, v13
    v_or_b32 v8, v8, v9
    v_bfe_u32 v9, v0, 1, 2
    v_mov_b32 v13, 0x0c0c0c0c
    v_cmp_eq_u32 vcc, 0, v9
    s_nop 1
    v_cndmask_b32 v228, v13, v8, vcc
    v_cmp_eq_u32 vcc, 1, v9
    s_nop 1
    v_cndmask_b32 v229, v13, v8, vcc
    v_cmp_eq_u32 vcc, 2, v9
    s_nop 1
    v_cndmask_b32 v230, v13, v8, vcc
    v_cmp_eq_u32 vcc, 3, v9
    s_nop 1
    v_cndmask_b32 v231, v13, v8, vcc
    s_mul_i32 s47, s41, 18
    s_add_u32 s47, s47, s45
    s_sub_u32 s47, s47, 2
    s_mov_b32 s48, s20
    s_mov_b32 s49, s21
    s_mov_b32 s50, 5308416
    s_mov_b32 s51, 0x20000
    s_mov_b32 s52, s24
    s_mov_b32 s53, s25
    s_mov_b32 s54, 5308416
    s_mov_b32 s55, 0x20000
    s_mov_b32 s12, s22
    s_mov_b32 s13, s23
    s_mov_b32 s14, 9216
    s_mov_b32 s15, 0x20000
    v_mul_u32_u24 v10, 9216, v4
    v_lshl_add_u32 v6, v10, 3, v5
    v_add_u32 v252, v10, v5
    v_lshlrev_b32 v3, 2, v4
    s_lshl_b32 s70, s77, 2
    s_add_u32 s70, s70, s46
    s_mul_i32 s18, s70, 288
    s_mul_i32 s70, s70, 663552
    s_lshr_b32 s39, s47, 1
    s_lshl_b32 s39, s39, 7
    s_add_u32 s70, s70, s39
    s_lshl_b32 s39, s47, 6
    s_lshl_b32 s19, s47, 9
    s_lshl_b32 s38, s46, 7
    s_add_u32 s19, s19, s38
    s_add_u32 s19, s19, 950144
    s_lshl_b32 s38, s77, 7
    s_add_u32 s19, s19, s38
    s_xor_b32 s16, s47, 1
    s_lshl_b32 s16, s16, 9
    s_add_u32 s16, s16, 950272
    s_mov_b32 s74, 0x000f000f
    s_lshl_b32 s38, s77, 2
    s_sub_u32 s38, 4, s38
    s_lshl_b32 s74, s74, s38
    s_mov_b32 s21, s74
    v_and_b32 v8, 1, v0
    v_lshlrev_b32 v8, 4, v8
    v_mov_b32 v9, 0xffff
    v_lshlrev_b32 v8, v8, v9
    v_bfe_u32 v9, v0, 1, 2
    v_cmp_eq_u32 vcc, 0, v9
    s_nop 1
    v_cndmask_b32 v232, 0, v8, vcc
    v_cmp_eq_u32 vcc, 1, v9
    s_nop 1
    v_cndmask_b32 v233, 0, v8, vcc
    v_cmp_eq_u32 vcc, 2, v9
    s_nop 1
    v_cndmask_b32 v234, 0, v8, vcc
    v_cmp_eq_u32 vcc, 3, v9
    s_nop 1
    v_cndmask_b32 v235, 0, v8, vcc
    v_and_b32 v8, 31, v0
    v_lshl_add_u32 v255, v8, 1, s39
    s_mov_b32 s56, s8
    s_mov_b32 s57, s9
    s_mov_b32 s58, 1152
    s_mov_b32 s59, 0x20000
    v_and_b32 v8, 1, v2
    v_lshlrev_b32 v8, 4, v8
    v_lshrrev_b32 v9, 1, v2
    v_lshl_add_u32 v8, v9, 3, v8
    v_mul_u32_u24 v8, 1152, v8
    v_lshl_add_u32 v8, v1, 4, v8
    v_cmp_gt_u32 vcc, 8, v1
    v_mov_b32 v9, 0x7fffffff
    s_nop 0
    v_cndmask_b32 v9, v9, v8, vcc
    s_mul_i32 s71, s47, 36864
    s_lshl_b32 s72, s46, 8
    s_add_u32 s72, s72, s71
    s_add_u32 s73, s72, 4608
    s_lshl_b32 s77, s40, 8
    s_mov_b32 s76, 2048
    v_mul_u32_u24 v54, 13824, v2
    v_lshl_add_u32 v54, v1, 4, v54
    v_add_u32 v54, s77, v54
    v_lshlrev_b32 v55, 3, v1
    v_lshl_add_u32 v55, v2, 1, v55
    s_lshr_b32 s38, s77, 1
    v_add_u32 v55, s38, v55
    v_mul_u32_u24 v70, 13824, v2
    v_lshl_add_u32 v70, v1, 4, v70
    v_add_u32 v70, s76, v70
    v_lshlrev_b32 v71, 3, v1
    v_lshl_add_u32 v71, v2, 1, v71
    s_lshr_b32 s38, s76, 1
    v_add_u32 v71, s38, v71
    s_cmp_lt_u32 s46, 2
    s_cbranch_scc0 L_mlpw_gate
    s_lshl_b32 s38, s45, 1
    s_add_u32 s38, s38, s46
    s_cmp_ge_u32 s38, 23
    s_cselect_b32 s38, 1, 0
    s_lshl_b32 s39, s41, 1
    s_add_u32 s38, s38, s39
    s_lshl_b32 s74, s38, 10
    s_add_u32 s74, s74, 77824
    v_lshlrev_b32 v10, 4, v0
    s_lshl_b32 s38, s46, 9
    s_add_u32 s38, s38, 128
    v_lshl_add_u32 v12, v0, 3, s38
    s_lshl_b32 s38, s46, 2
    s_add_u32 s38, s38, 96
    v_mov_b32 v13, s38
    s_getreg_b32 s69, hwreg(HW_REG_XCC_ID, 0, 4)
    s_lshl_b32 s69, s69, 8
    s_or_b32 s69, s69, 0x1000
    v_mov_b32 v11, 104
    s_mov_b32 s68, 0
L_go:
    ds_read_b32 v14, v11
    s_waitcnt lgkmcnt(0)
    v_cmp_le_u32 vcc, 2, v14
    s_cbranch_vccnz L_go_ok
    s_sleep 4
    s_add_u32 s68, s68, 1
    s_cmp_lt_u32 s68, 320000
    s_cbranch_scc1 L_go
L_go_ok:
    s_setprio 3
    buffer_load_dwordx4 v[16:19], v10, s[60:63], s74 offen sc1
    s_sleep 8
    buffer_load_dwordx4 v[20:23], v10, s[60:63], s74 offen sc1
    s_sleep 8
    buffer_load_dwordx4 v[24:27], v10, s[60:63], s74 offen sc1
    s_mov_b32 s68, 0
L_qp_loop:
    s_waitcnt vmcnt(2)
    v_xor_b32 v16, s92, v16
    v_xor_b32 v17, s93, v17
    v_xor_b32 v18, s94, v18
    v_xor_b32 v19, s95, v19
    v_or3_b32 v14, v16, v17, v18
    v_or_b32 v14, v14, v19
    v_and_b32 v14, 0xff, v14
    v_cmp_ne_u32 vcc, 0, v14
    s_cbranch_vccz L_qp_ok0
    buffer_load_dwordx4 v[16:19], v10, s[60:63], s74 offen sc1
    s_waitcnt vmcnt(2)
    v_xor_b32 v20, s92, v20
    v_xor_b32 v21, s93, v21
    v_xor_b32 v22, s94, v22
    v_xor_b32 v23, s95, v23
    v_or3_b32 v14, v20, v21, v22
    v_or_b32 v14, v14, v23
    v_and_b32 v14, 0xff, v14
    v_cmp_ne_u32 vcc, 0, v14
    s_cbranch_vccz L_qp_ok1
    buffer_load_dwordx4 v[20:23], v10, s[60:63], s74 offen sc1
    s_waitcnt vmcnt(2)
    v_xor_b32 v24, s92, v24
    v_xor_b32 v25, s93, v25
    v_xor_b32 v26, s94, v26
    v_xor_b32 v27, s95, v27
    v_or3_b32 v14, v24, v25, v26
    v_or_b32 v14, v14, v27
    v_and_b32 v14, 0xff, v14
    v_cmp_ne_u32 vcc, 0, v14
    s_cbranch_vccz L_qp_ok2
    buffer_load_dwordx4 v[24:27], v10, s[60:63], s74 offen sc1
    s_add_u32 s68, s68, 1
    s_cmp_lt_u32 s68, 40000
    s_cbranch_scc1 L_qp_loop
    s_waitcnt vmcnt(0)
L_qp_ok2:
    s_mov_b32 s38, 0x07060302
    v_perm_b32 v14, v25, v24, s38
    v_perm_b32 v15, v27, v26, s38
    v_and_b32 v11, 0x1f00, v24
    s_branch L_qp_got
L_qp_ok1:
    s_mov_b32 s38, 0x07060302
    v_perm_b32 v14, v21, v20, s38
    v_perm_b32 v15, v23, v22, s38
    v_and_b32 v11, 0x1f00, v20
    s_branch L_qp_got
L_qp_ok0:
    s_mov_b32 s38, 0x07060302
    v_perm_b32 v14, v17, v16, s38
    v_perm_b32 v15, v19, v18, s38
    v_and_b32 v11, 0x1f00, v16
L_qp_got:
    ds_write_b64 v12, v[14:15]
    v_cmp_ne_u32 vcc, s69, v11
    s_cmp_eq_u64 vcc, 0
    s_cselect_b32 s69, 2, 1
    v_mov_b32 v11, s69
    ds_write_b32 v13, v11
    s_waitcnt lgkmcnt(0)
    s_setprio 0
    s_sub_u32 s38, s45, 2
    s_cmp_lt_u32 s38, 18
    s_cbranch_scc0 L_att_exit
L_mlpw_gate:
    v_mov_b32 v11, 108
    s_mov_b32 s68, 0
L_mg:
    ds_read_b32 v14, v11
    s_waitcnt lgkmcnt(0)
    v_cmp_le_u32 vcc, 4, v14
    s_cbranch_vccnz L_mg_ok
    s_sleep 2
    s_add_u32 s68, s68, 1
    s_cmp_lt_u32 s68, 320000
    s_cbranch_scc1 L_mg
L_mg_ok:
    s_cmp_eq_u32 s46, 0
    s_cbranch_scc0 L_mlp_c1
    s_mov_b32 s38, 8704
    s_mov_b32 s39, 13312
    buffer_load_dwordx4 v[56:59], v70, s[60:63], s38 offen sc1
    buffer_load_dwordx4 v[60:63], v70, s[60:63], s38 offen offset:2304 sc1
    buffer_load_dwordx4 v[64:67], v70, s[60:63], s39 offen sc1
    buffer_load_ushort v68, v71, s[56:59], 0 offen
L_mlp_c1:
    s_mov_b32 s38, 8704
    s_mov_b32 s39, 13312
    buffer_load_dwordx4 v[40:43], v54, s[60:63], s38 offen sc1
    buffer_load_dwordx4 v[44:47], v54, s[60:63], s38 offen offset:2304 sc1
    buffer_load_dwordx4 v[48:51], v54, s[60:63], s39 offen sc1
    buffer_load_ushort v52, v55, s[56:59], 0 offen
    buffer_load_ushort v255, v255, s[12:15], 0 offen nt
    v_mov_b32 v11, 112
    s_waitcnt vmcnt(29)
    buffer_load_dwordx4 v[72:75], v6, s[48:51], s70 offen nt
    s_add_u32 s70, s70, 9216
    ds_read_b32 v14, v11
    s_waitcnt lgkmcnt(0)
    v_cmp_ne_u32 vcc, 0, v14
    s_cbranch_vccnz L_mh_1
    s_waitcnt vmcnt(29)
    buffer_load_dwordx4 v[108:111], v8, s[52:55], s72 offen offset:0 nt
    ds_read_b32 v14, v11
    s_waitcnt lgkmcnt(0)
    v_cmp_ne_u32 vcc, 0, v14
    s_cbranch_vccnz L_mh_2
    s_waitcnt vmcnt(29)
    buffer_load_dwordx4 v[76:79], v6, s[48:51], s70 offen nt
    s_add_u32 s70, s70, 9216
    ds_read_b32 v14, v11
    s_waitcnt lgkmcnt(0)
    v_cmp_ne_u32 vcc, 0, v14
    s_cbranch_vccnz L_mh_3
    s_waitcnt vmcnt(29)
    buffer_load_dwordx4 v[112:115], v8, s[52:55], s72 offen offset:1152 nt
    ds_read_b32 v14, v11
    s_waitcnt lgkmcnt(0)
    v_cmp_ne_u32 vcc, 0, v14
    s_cbranch_vccnz L_mh_4
    s_waitcnt vmcnt(29)
    buffer_load_dwordx4 v[80:83], v6, s[48:51], s70 offen nt
    s_add_u32 s70, s70, 9216
    ds_read_b32 v14, v11
    s_waitcnt lgkmcnt(0)
    v_cmp_ne_u32 vcc, 0, v14
    s_cbranch_vccnz L_mh_5
    s_waitcnt vmcnt(29)
    buffer_load_dwordx4 v[116:119], v8, s[52:55], s72 offen offset:2304 nt
    ds_read_b32 v14, v11
    s_waitcnt lgkmcnt(0)
    v_cmp_ne_u32 vcc, 0, v14
    s_cbranch_vccnz L_mh_6
    s_waitcnt vmcnt(29)
    buffer_load_dwordx4 v[84:87], v6, s[48:51], s70 offen nt
    s_add_u32 s70, s70, 9216
    ds_read_b32 v14, v11
    s_waitcnt lgkmcnt(0)
    v_cmp_ne_u32 vcc, 0, v14
    s_cbranch_vccnz L_mh_7
    s_waitcnt vmcnt(29)
    buffer_load_dwordx4 v[120:123], v8, s[52:55], s72 offen offset:3456 nt
    ds_read_b32 v14, v11
    s_waitcnt lgkmcnt(0)
    v_cmp_ne_u32 vcc, 0, v14
    s_cbranch_vccnz L_mh_8
    s_waitcnt vmcnt(29)
    buffer_load_dwordx4 v[88:91], v6, s[48:51], s70 offen nt
    s_add_u32 s70, s70, 9216
    ds_read_b32 v14, v11
    s_waitcnt lgkmcnt(0)
    v_cmp_ne_u32 vcc, 0, v14
    s_cbranch_vccnz L_mh_9
    s_waitcnt vmcnt(29)
    buffer_load_dwordx4 v[124:127], v8, s[52:55], s73 offen offset:0 nt
    ds_read_b32 v14, v11
    s_waitcnt lgkmcnt(0)
    v_cmp_ne_u32 vcc, 0, v14
    s_cbranch_vccnz L_mh_10
    s_waitcnt vmcnt(29)
    buffer_load_dwordx4 v[92:95], v6, s[48:51], s70 offen nt
    s_add_u32 s70, s70, 9216
    ds_read_b32 v14, v11
    s_waitcnt lgkmcnt(0)
    v_cmp_ne_u32 vcc, 0, v14
    s_cbranch_vccnz L_mh_11
    s_waitcnt vmcnt(29)
    buffer_load_dwordx4 v[128:131], v8, s[52:55], s73 offen offset:1152 nt
    ds_read_b32 v14, v11
    s_waitcnt lgkmcnt(0)
    v_cmp_ne_u32 vcc, 0, v14
    s_cbranch_vccnz L_mh_12
    s_waitcnt vmcnt(29)
    buffer_load_dwordx4 v[96:99], v6, s[48:51], s70 offen nt
    s_add_u32 s70, s70, 9216
    ds_read_b32 v14, v11
    s_waitcnt lgkmcnt(0)
    v_cmp_ne_u32 vcc, 0, v14
    s_cbranch_vccnz L_mh_13
    s_waitcnt vmcnt(29)
    buffer_load_dwordx4 v[132:135], v8, s[52:55], s73 offen offset:2304 nt
    ds_read_b32 v14, v11
    s_waitcnt lgkmcnt(0)
    v_cmp_ne_u32 vcc, 0, v14
    s_cbranch_vccnz L_mh_14
    s_waitcnt vmcnt(29)
    buffer_load_dwordx4 v[100:103], v6, s[48:51], s70 offen nt
    s_add_u32 s70, s70, 525312
    ds_read_b32 v14, v11
    s_waitcnt lgkmcnt(0)
    v_cmp_ne_u32 vcc, 0, v14
    s_cbranch_vccnz L_mh_15
    s_waitcnt vmcnt(29)
    buffer_load_dwordx4 v[136:139], v8, s[52:55], s73 offen offset:3456 nt
    ds_read_b32 v14, v11
    s_waitcnt lgkmcnt(0)
    v_cmp_ne_u32 vcc, 0, v14
    s_cbranch_vccnz L_mh_16
    s_waitcnt vmcnt(29)
    buffer_load_dwordx4 v[104:107], v252, s[48:51], s70 offen nt
    s_branch L_mb_17
L_mb_1:
    buffer_load_dwordx4 v[108:111], v8, s[52:55], s72 offen offset:0 nt
L_mb_2:
    buffer_load_dwordx4 v[76:79], v6, s[48:51], s70 offen nt
    s_add_u32 s70, s70, 9216
L_mb_3:
    buffer_load_dwordx4 v[112:115], v8, s[52:55], s72 offen offset:1152 nt
L_mb_4:
    buffer_load_dwordx4 v[80:83], v6, s[48:51], s70 offen nt
    s_add_u32 s70, s70, 9216
L_mb_5:
    buffer_load_dwordx4 v[116:119], v8, s[52:55], s72 offen offset:2304 nt
L_mb_6:
    buffer_load_dwordx4 v[84:87], v6, s[48:51], s70 offen nt
    s_add_u32 s70, s70, 9216
L_mb_7:
    buffer_load_dwordx4 v[120:123], v8, s[52:55], s72 offen offset:3456 nt
L_mb_8:
    buffer_load_dwordx4 v[88:91], v6, s[48:51], s70 offen nt
    s_add_u32 s70, s70, 9216
L_mb_9:
    buffer_load_dwordx4 v[124:127], v8, s[52:55], s73 offen offset:0 nt
L_mb_10:
    buffer_load_dwordx4 v[92:95], v6, s[48:51], s70 offen nt
    s_add_u32 s70, s70, 9216
L_mb_11:
    buffer_load_dwordx4 v[128:131], v8, s[52:55], s73 offen offset:1152 nt
L_mb_12:
    buffer_load_dwordx4 v[96:99], v6, s[48:51], s70 offen nt
    s_add_u32 s70, s70, 9216
L_mb_13:
    buffer_load_dwordx4 v[132:135], v8, s[52:55], s73 offen offset:2304 nt
L_mb_14:
    buffer_load_dwordx4 v[100:103], v6, s[48:51], s70 offen nt
    s_add_u32 s70, s70, 525312
L_mb_15:
    buffer_load_dwordx4 v[136:139], v8, s[52:55], s73 offen offset:3456 nt
L_mb_16:
    buffer_load_dwordx4 v[104:107], v252, s[48:51], s70 offen nt
L_mb_17:
    s_cmp_eq_u32 s46, 3
    s_cbranch_scc0 L_mlp_issued
    s_add_u32 s72, s71, 1024
    s_add_u32 s73, s72, 4608
    buffer_load_dwordx4 v[140:143], v9, s[52:55], s72 offen offset:0 nt
    buffer_load_dwordx4 v[144:147], v9, s[52:55], s72 offen offset:1152 nt
    buffer_load_dwordx4 v[148:151], v9, s[52:55], s72 offen offset:2304 nt
    buffer_load_dwordx4 v[152:155], v9, s[52:55], s72 offen offset:3456 nt
    buffer_load_dwordx4 v[156:159], v9, s[52:55], s73 offen offset:0 nt
    buffer_load_dwordx4 v[160:163], v9, s[52:55], s73 offen offset:1152 nt
    buffer_load_dwordx4 v[164:167], v9, s[52:55], s73 offen offset:2304 nt
    buffer_load_dwordx4 v[168:171], v9, s[52:55], s73 offen offset:3456 nt
L_mlp_issued:
    buffer_load_dword v30, v227, s[60:63], s16 offen sc1
    buffer_load_dword v31, v227, s[60:63], s16 offen offset:128 sc1
    s_waitcnt vmcnt(19)
L_s4:
    s_setprio 3
    s_mov_b32 s78, 0x00010001
    s_mov_b32 s79, 0x00010001
    s_mul_i32 s74, s41, 18432
    s_add_u32 s74, s74, 2097152
    s_add_u32 s75, s74, 9216
    v_lshlrev_b32 v26, 2, v0
    v_add_u32 v27, 18816, v26
    v_add_u32 v26, s18, v26
    v_add_u32 v3, s18, v3
    v_cmp_eq_u32 vcc, 1, v1
    v_cmp_eq_u32 s[38:39], 12, v1
    v_mov_b32 v29, 0x3727c5ac
    s_or_b64 vcc, vcc, s[38:39]
    s_nop 1
    v_cndmask_b32 v28, 0, v29, vcc
    v_mov_b32 v29, 0
    s_cmp_eq_u32 s40, 4
    s_cbranch_scc0 L_s4_one
    s_mov_b32 s68, 0
L_cst_1:
    v_xor_b32 v40, s92, v40
    v_xor_b32 v41, s93, v41
    v_xor_b32 v42, s94, v42
    v_xor_b32 v43, s95, v43
    v_or3_b32 v4, v40, v41, v42
    v_xor_b32 v44, s92, v44
    v_xor_b32 v45, s93, v45
    v_xor_b32 v46, s94, v46
    v_xor_b32 v47, s95, v47
    v_or3_b32 v4, v4, v43, v44
    v_or3_b32 v4, v4, v45, v46
    v_xor_b32 v48, s92, v48
    v_xor_b32 v49, s93, v49
    v_xor_b32 v50, s94, v50
    v_xor_b32 v51, s95, v51
    v_or3_b32 v4, v4, v47, v48
    v_or3_b32 v4, v4, v49, v50
    v_or_b32 v4, v4, v51
    v_and_b32 v4, 0xff, v4
    v_cmp_ne_u32 vcc, 0, v4
    s_cbranch_vccnz L_cstr_2
L_cst_1_ok:
    v_permlane32_swap_b32 v40, v42
    v_permlane32_swap_b32 v41, v43
    v_add_f32 v40, v40, v42
    v_add_f32 v41, v41, v43
    s_nop 1
    v_permlane16_swap_b32 v40, v41
    v_add_f32 v40, v40, v41
    v_permlane32_swap_b32 v44, v46
    v_permlane32_swap_b32 v45, v47
    v_add_f32 v44, v44, v46
    v_add_f32 v45, v45, v47
    s_nop 1
    v_permlane16_swap_b32 v44, v45
    v_add_f32 v44, v44, v45
    v_permlane32_swap_b32 v48, v50
    v_permlane32_swap_b32 v49, v51
    v_add_f32 v48, v48, v50
    v_add_f32 v49, v49, v51
    s_nop 1
    v_permlane16_swap_b32 v48, v49
    v_add_f32 v48, v48, v49
    v_cvt_pk_bf16_f32 v4, v40, v44
    v_lshlrev_b32 v40, 16, v4
    v_and_b32 v44, 0xffff0000, v4
    v_cvt_pk_bf16_f32 v48, v48, v48
    v_and_b32 v48, 0xffff0000, v48
    v_lshlrev_b32 v8, 16, v52
    v_mov_b32 v9, v40
    v_mov_b32 v11, v44
    v_add_f32 v10, 1.0, v48
    v_cvt_pk_bf16_f32 v10, v10, v10
    v_and_b32 v10, 0xffff0000, v10
    v_lshlrev_b32 v12, 4, v1
    v_lshl_add_u32 v12, v2, 2, v12
    v_add_u32 v12, s77, v12
    ds_write_b32 v12, v10 offset:14208
    ds_write_b32 v12, v11 offset:16512
    s_lshr_b32 s38, s77, 2
    s_add_u32 s38, s38, 18816
    v_and_b32 v14, 1, v2
    v_lshlrev_b32 v14, 3, v14
    v_lshrrev_b32 v15, 1, v2
    v_lshlrev_b32 v15, 2, v15
    v_add3_u32 v14, v14, v15, s38
    v_add3_u32 v15, v15, 16, s38
    v_add_u32 v16, 32, v14
    v_add_u32 v17, 32, v15
    v_add_f32 v11, v11, v11
    v_mov_b32 v18, v10
    v_mul_f32 v19, v10, v10
    v_mul_f32 v20, v10, v11
    v_mul_f32 v21, 0.5, v11
    v_mul_f32 v22, v21, v21
    v_mov_b32 v23, 0
    v_add_f32 v25, v10, v10
    v_mul_u32_u24 v13, 2304, v2
    v_lshl_add_u32 v13, v1, 4, v13
    v_add_u32 v13, s77, v13
    s_mov_b32 s68, 0
L_cst_3:
    v_xor_b32 v56, s92, v56
    v_xor_b32 v57, s93, v57
    v_xor_b32 v58, s94, v58
    v_xor_b32 v59, s95, v59
    v_or3_b32 v4, v56, v57, v58
    v_xor_b32 v60, s92, v60
    v_xor_b32 v61, s93, v61
    v_xor_b32 v62, s94, v62
    v_xor_b32 v63, s95, v63
    v_or3_b32 v4, v4, v59, v60
    v_or3_b32 v4, v4, v61, v62
    v_xor_b32 v64, s92, v64
    v_xor_b32 v65, s93, v65
    v_xor_b32 v66, s94, v66
    v_xor_b32 v67, s95, v67
    v_or3_b32 v4, v4, v63, v64
    v_or3_b32 v4, v4, v65, v66
    v_or_b32 v4, v4, v67
    v_and_b32 v4, 0xff, v4
    v_cmp_ne_u32 vcc, 0, v4
    s_cbranch_vccnz L_cstr_4
L_cst_3_ok:
    v_permlane32_swap_b32 v56, v58
    v_permlane32_swap_b32 v57, v59
    v_add_f32 v56, v56, v58
    v_add_f32 v57, v57, v59
    s_nop 1
    v_permlane16_swap_b32 v56, v57
    v_add_f32 v56, v56, v57
    v_permlane32_swap_b32 v60, v62
    v_permlane32_swap_b32 v61, v63
    v_add_f32 v60, v60, v62
    v_add_f32 v61, v61, v63
    s_nop 1
    v_permlane16_swap_b32 v60, v61
    v_add_f32 v60, v60, v61
    v_permlane32_swap_b32 v64, v66
    v_permlane32_swap_b32 v65, v67
    v_add_f32 v64, v64, v66
    v_add_f32 v65, v65, v67
    s_nop 1
    v_permlane16_swap_b32 v64, v65
    v_add_f32 v64, v64, v65
    v_cvt_pk_bf16_f32 v4, v56, v60
    v_lshlrev_b32 v56, 16, v4
    v_and_b32 v60, 0xffff0000, v4
    v_cvt_pk_bf16_f32 v64, v64, v64
    v_and_b32 v64, 0xffff0000, v64
    v_lshlrev_b32 v32, 16, v68
    v_mov_b32 v33, v56
    v_mov_b32 v35, v60
    v_add_f32 v34, 1.0, v64
    v_cvt_pk_bf16_f32 v34, v34, v34
    v_and_b32 v34, 0xffff0000, v34
    v_lshlrev_b32 v36, 4, v1
    v_lshl_add_u32 v36, v2, 2, v36
    v_add_u32 v36, s76, v36
    ds_write_b32 v36, v34 offset:14208
    ds_write_b32 v36, v35 offset:16512
    v_add_f32 v35, v35, v35
    v_mov_b32 v42, v34
    v_mul_f32 v43, v34, v34
    v_mul_f32 v44, v34, v35
    v_mul_f32 v45, 0.5, v35
    v_mul_f32 v46, v45, v45
    v_mov_b32 v47, 0
    v_add_f32 v18, v18, v42
    v_add_f32 v19, v19, v43
    v_add_f32 v20, v20, v44
    v_add_f32 v21, v21, v45
    v_add_f32 v22, v22, v46
    v_permlane32_swap_b32 v18, v19
    v_permlane32_swap_b32 v20, v21
    v_permlane32_swap_b32 v22, v23
    v_add_f32 v18, v18, v19
    v_add_f32 v20, v20, v21
    v_add_f32 v22, v22, v23
    v_mov_b32 v24, v22
    v_permlane16_swap_b32 v18, v20
    s_nop 0
    v_permlane16_swap_b32 v24, v22
    v_add_f32 v18, v18, v20
    v_add_f32 v22, v22, v24
    s_nop 0
    v_add_f32_dpp v18, v18, v18 quad_perm:[1,0,3,2] row_mask:0xf bank_mask:0xf
    v_add_f32_dpp v22, v22, v22 quad_perm:[1,0,3,2] row_mask:0xf bank_mask:0xf
    s_nop 0
    v_add_f32_dpp v18, v18, v18 quad_perm:[2,3,0,1] row_mask:0xf bank_mask:0xf
    v_add_f32_dpp v22, v22, v22 quad_perm:[2,3,0,1] row_mask:0xf bank_mask:0xf
    s_nop 0
    v_add_f32_dpp v18, v18, v18 row_half_mirror row_mask:0xf bank_mask:0xf
    v_add_f32_dpp v22, v22, v22 row_half_mirror row_mask:0xf bank_mask:0xf
    s_nop 0
    v_add_f32_dpp v18, v18, v18 row_mirror row_mask:0xf bank_mask:0xf
    v_add_f32_dpp v22, v22, v22 row_mirror row_mask:0xf bank_mask:0xf
    s_mov_b64 exec, s[78:79]
    ds_write_b32 v16, v18
    ds_write_b32 v17, v22
    s_mov_b64 exec, -1
    v_add_f32 v49, v34, v34
    v_mul_u32_u24 v37, 2304, v2
    v_lshl_add_u32 v37, v1, 4, v37
    v_add_u32 v37, s76, v37
    s_cmp_ge_u32 s40, 4
    s_cbranch_scc0 L_wdb0
    s_waitcnt vmcnt(30)
    v_mov_b32 v4, 116
    v_mov_b32 v5, 1
    s_mov_b64 exec, 1
    ds_add_u32 v4, v5
    s_mov_b64 exec, -1
L_wdb0:
    v_mov_b32 v4, 116
    s_mov_b32 s68, 0
L_wdb:
    ds_read_b32 v5, v4
    s_waitcnt lgkmcnt(0)
    v_cmp_le_u32 vcc, 4, v5
    s_cbranch_vccnz L_wdb_ok
    s_sleep 1
    s_add_u32 s68, s68, 1
    s_cmp_lt_u32 s68, 320000
    s_cbranch_scc1 L_wdb
L_wdb_ok:
    s_mov_b32 s68, 0
L_poll_5:
    buffer_load_dwordx4 v[56:59], v13, s[60:63], s74 offen sc1
    buffer_load_dwordx4 v[60:63], v13, s[60:63], s75 offen sc1
    buffer_load_dwordx4 v[64:67], v37, s[60:63], s74 offen sc1
    buffer_load_dwordx4 v[68:71], v37, s[60:63], s75 offen sc1
    s_waitcnt vmcnt(3)
    v_xor_b32 v56, s92, v56
    v_xor_b32 v57, s93, v57
    v_xor_b32 v58, s94, v58
    v_xor_b32 v59, s95, v59
    v_or3_b32 v4, v56, v57, v58
    s_waitcnt vmcnt(2)
    v_xor_b32 v60, s92, v60
    v_xor_b32 v61, s93, v61
    v_xor_b32 v62, s94, v62
    v_xor_b32 v63, s95, v63
    v_or3_b32 v4, v4, v59, v60
    v_or3_b32 v4, v4, v61, v62
    s_waitcnt vmcnt(1)
    v_xor_b32 v64, s92, v64
    v_xor_b32 v65, s93, v65
    v_xor_b32 v66, s94, v66
    v_xor_b32 v67, s95, v67
    v_or3_b32 v4, v4, v63, v64
    v_or3_b32 v4, v4, v65, v66
    s_waitcnt vmcnt(0)
    v_xor_b32 v68, s92, v68
    v_xor_b32 v69, s93, v69
    v_xor_b32 v70, s94, v70
    v_xor_b32 v71, s95, v71
    v_or3_b32 v4, v4, v67, v68
    v_or3_b32 v4, v4, v69, v70
    v_or_b32 v4, v4, v71
    v_and_b32 v4, 0xff, v4
    v_cmp_ne_u32 vcc, 0, v4
    s_cbranch_vccnz L_poll_5_r
L_poll_5_ok:
    v_pk_add_f32 v[56:57], v[56:57], v[60:61]
    v_pk_add_f32 v[58:59], v[58:59], v[62:63]
    v_pk_add_f32 v[64:65], v[64:65], v[68:69]
    v_pk_add_f32 v[66:67], v[66:67], v[70:71]
    v_permlane32_swap_b32 v56, v58
    v_permlane32_swap_b32 v57, v59
    v_permlane32_swap_b32 v64, v66
    v_permlane32_swap_b32 v65, v67
    v_add_f32 v56, v56, v58
    v_add_f32 v57, v57, v59
    v_add_f32 v64, v64, v66
    v_add_f32 v65, v65, v67
    v_permlane16_swap_b32 v56, v57
    s_nop 0
    v_permlane16_swap_b32 v64, v65
    v_add_f32 v56, v56, v57
    v_add_f32 v64, v64, v65
    v_fma_f32 v18, v9, v56, v8
    v_mul_f32 v20, v10, v18
    v_mul_f32 v19, v18, v18
    ds_write_b32 v12, v20 offset:11904
    v_mul_f32 v21, v25, v20
    v_mul_f32 v22, v20, v20
    v_mul_f32 v23, v11, v20
    v_fma_f32 v42, v33, v64, v32
    v_mul_f32 v44, v34, v42
    v_mul_f32 v43, v42, v42
    ds_write_b32 v36, v44 offset:11904
    v_mul_f32 v45, v49, v44
    v_mul_f32 v46, v44, v44
    v_mul_f32 v47, v35, v44
    v_pk_add_f32 v[18:19], v[18:19], v[42:43]
    v_pk_add_f32 v[20:21], v[20:21], v[44:45]
    v_pk_add_f32 v[22:23], v[22:23], v[46:47]
    v_permlane32_swap_b32 v18, v19
    v_permlane32_swap_b32 v20, v21
    v_permlane32_swap_b32 v22, v23
    v_add_f32 v18, v18, v19
    v_add_f32 v20, v20, v21
    v_add_f32 v22, v22, v23
    v_mov_b32 v24, v22
    v_permlane16_swap_b32 v18, v20
    s_nop 0
    v_permlane16_swap_b32 v24, v22
    v_add_f32 v18, v18, v20
    v_add_f32 v22, v22, v24
    s_nop 0
    v_add_f32_dpp v18, v18, v18 quad_perm:[1,0,3,2] row_mask:0xf bank_mask:0xf
    v_add_f32_dpp v22, v22, v22 quad_perm:[1,0,3,2] row_mask:0xf bank_mask:0xf
    s_nop 0
    v_add_f32_dpp v18, v18, v18 quad_perm:[2,3,0,1] row_mask:0xf bank_mask:0xf
    v_add_f32_dpp v22, v22, v22 quad_perm:[2,3,0,1] row_mask:0xf bank_mask:0xf
    s_nop 0
    v_add_f32_dpp v18, v18, v18 row_half_mirror row_mask:0xf bank_mask:0xf
    v_add_f32_dpp v22, v22, v22 row_half_mirror row_mask:0xf bank_mask:0xf
    s_nop 0
    v_add_f32_dpp v18, v18, v18 row_mirror row_mask:0xf bank_mask:0xf
    v_add_f32_dpp v22, v22, v22 row_mirror row_mask:0xf bank_mask:0xf
    s_mov_b64 exec, s[78:79]
    ds_write_b32 v14, v18
    ds_write_b32 v15, v22
    s_mov_b64 exec, -1
L_s4_bar:
    s_waitcnt lgkmcnt(0)
    s_barrier
    s_cmp_ge_u32 s40, 4
    s_cbranch_scc0 L_att_exit
    ds_read2st64_b32 v[10:11], v27 offset0:0 offset1:1
    ds_read_b32 v16, v26 offset:11904
    ds_read_b32 v17, v3 offset:12160
    ds_read_b32 v20, v26 offset:14208
    ds_read_b32 v21, v3 offset:14464
    ds_read_b32 v24, v26 offset:16512
    ds_read_b32 v25, v3 offset:16768
    v_mov_b32 v12, 0x3ae38e39
    s_waitcnt lgkmcnt(6)
    v_add_f32 v10, v10, v11
    v_mov_b32 v11, v10
    s_nop 1
    v_permlane16_swap_b32 v11, v10
    v_add_f32 v10, v10, v11
    v_mov_b32 v11, v10
    s_nop 1
    v_permlane32_swap_b32 v11, v10
    v_add_f32 v10, v10, v11
    v_fma_f32 v10, v10, v12, v28
    s_nop 1
    v_subrev_f32_dpp v30, v10, v29 row_newbcast:0 row_mask:0xf bank_mask:0xf
    v_mov_b32_dpp v31, v10 row_newbcast:1 row_mask:0xf bank_mask:0xf
    v_mov_b32_dpp v32, v10 row_newbcast:2 row_mask:0xf bank_mask:0xf
    v_mov_b32_dpp v33, v10 row_newbcast:3 row_mask:0xf bank_mask:0xf
    v_mov_b32_dpp v35, v10 row_newbcast:5 row_mask:0xf bank_mask:0xf
    v_mov_b32_dpp v34, v10 row_newbcast:4 row_mask:0xf bank_mask:0xf
    v_mov_b32_dpp v36, v10 row_newbcast:11 row_mask:0xf bank_mask:0xf
    v_mov_b32_dpp v37, v10 row_newbcast:12 row_mask:0xf bank_mask:0xf
    v_fmac_f32_dpp v31, v10, v30 row_newbcast:0 row_mask:0xf bank_mask:0xf
    v_fmac_f32_dpp v33, v10, v30 row_newbcast:9 row_mask:0xf bank_mask:0xf
    v_rsq_f32 v31, v31
    v_fmac_f32_dpp v32, v10, v30 row_newbcast:8 row_mask:0xf bank_mask:0xf
    v_fmac_f32_dpp v35, v10, v30 row_newbcast:10 row_mask:0xf bank_mask:0xf
    v_fmac_f32 v34, v33, v30
    v_fmac_f32 v36, v31, v32
    v_fmac_f32 v35, v31, v34
    v_fmac_f32 v37, v31, v35
    v_fma_f32 v37, -v36, v36, v37
    v_mul_f32 v30, v30, v31
    v_rsq_f32 v37, v37
    s_waitcnt lgkmcnt(0)
    v_sub_f32 v24, v24, v36
    v_sub_f32 v25, v25, v36
    v_fmac_f32 v24, v30, v20
    v_fmac_f32 v25, v30, v21
    v_fmac_f32 v24, v31, v16
    v_fmac_f32 v25, v31, v17
    v_mul_f32 v24, v37, v24
    v_mul_f32 v25, v37, v25
    s_nop 0
    v_mov_b32_dpp v22, v24 row_ror:8 row_mask:0xf bank_mask:0xf
    v_mov_b32_dpp v23, v25 row_ror:8 row_mask:0xf bank_mask:0xf
    v_cvt_pk_bf16_f32 v24, v24, v22
    v_cvt_pk_bf16_f32 v25, v25, v23
    s_nop 0
    v_mov_b32_dpp v22, v24 row_newbcast:0 row_mask:0xf bank_mask:0xf
    v_mov_b32_dpp v23, v24 row_newbcast:1 row_mask:0xf bank_mask:0xf
    v_perm_b32 v244, v22, v22, v228
    v_perm_b32 v245, v22, v22, v229
    v_perm_b32 v246, v22, v22, v230
    v_perm_b32 v247, v22, v22, v231
    v_perm_b32 v248, v23, v23, v228
    v_perm_b32 v249, v23, v23, v229
    v_perm_b32 v250, v23, v23, v230
    v_perm_b32 v251, v23, v23, v231
    v_mfma_f32_16x16x32_bf16 v[240:243], v[244:247], v[72:75], 0
    v_mov_b32_dpp v22, v24 row_newbcast:2 row_mask:0xf bank_mask:0xf
    v_perm_b32 v244, v22, v22, v228
    v_perm_b32 v245, v22, v22, v229
    v_perm_b32 v246, v22, v22, v230
    v_perm_b32 v247, v22, v22, v231
    v_mfma_f32_16x16x32_bf16 v[240:243], v[248:251], v[76:79], v[240:243]
    v_mov_b32_dpp v23, v24 row_newbcast:3 row_mask:0xf bank_mask:0xf
    v_perm_b32 v248, v23, v23, v228
    v_perm_b32 v249, v23, v23, v229
    v_perm_b32 v250, v23, v23, v230
    v_perm_b32 v251, v23, v23, v231
    v_mfma_f32_16x16x32_bf16 v[240:243], v[244:247], v[80:83], v[240:243]
    v_mov_b32_dpp v22, v24 row_newbcast:4 row_mask:0xf bank_mask:0xf
    v_perm_b32 v244, v22, v22, v228
    v_perm_b32 v245, v22, v22, v229
    v_perm_b32 v246, v22, v22, v230
    v_perm_b32 v247, v22, v22, v231
    v_mfma_f32_16x16x32_bf16 v[240:243], v[248:251], v[84:87], v[240:243]
    v_mov_b32_dpp v23, v24 row_newbcast:5 row_mask:0xf bank_mask:0xf
    v_perm_b32 v248, v23, v23, v228
    v_perm_b32 v249, v23, v23, v229
    v_perm_b32 v250, v23, v23, v230
    v_perm_b32 v251, v23, v23, v231
    v_mfma_f32_16x16x32_bf16 v[240:243], v[244:247], v[88:91], v[240:243]
    v_mov_b32_dpp v22, v24 row_newbcast:6 row_mask:0xf bank_mask:0xf
    v_perm_b32 v244, v22, v22, v228
    v_perm_b32 v245, v22, v22, v229
    v_perm_b32 v246, v22, v22, v230
    v_perm_b32 v247, v22, v22, v231
    v_mfma_f32_16x16x32_bf16 v[240:243], v[248:251], v[92:95], v[240:243]
    v_mov_b32_dpp v23, v24 row_newbcast:7 row_mask:0xf bank_mask:0xf
    v_perm_b32 v248, v23, v23, v228
    v_perm_b32 v249, v23, v23, v229
    v_perm_b32 v250, v23, v23, v230
    v_perm_b32 v251, v23, v23, v231
    v_mfma_f32_16x16x32_bf16 v[240:243], v[244:247], v[96:99], v[240:243]
    v_mov_b32_dpp v22, v25 row_newbcast:0 row_mask:0xf bank_mask:0xf
    v_perm_b32 v244, v22, v22, v228
    v_perm_b32 v245, v22, v22, v229
    v_perm_b32 v246, v22, v22, v230
    v_perm_b32 v247, v22, v22, v231
    v_mfma_f32_16x16x32_bf16 v[240:243], v[248:251], v[100:103], v[240:243]
    s_nop 0
    v_mfma_f32_16x16x32_bf16 v[240:243], v[244:247], v[104:107], v[240:243]
    v_lshlrev_b32 v255, 16, v255
    v_lshlrev_b32 v8, 5, v1
    v_lshl_add_u32 v8, v2, 4, v8
    v_and_b32 v10, 3, v0
    v_lshlrev_b32 v9, 3, v10
    v_lshrrev_b32 v9, v9, v7
    v_and_b32 v9, 0xff, v9
    s_mul_i32 s38, s47, 2304
    s_add_u32 s38, s38, 333824
    v_permlane32_swap_b32 v240, v244
    v_permlane32_swap_b32 v241, v245
    v_permlane32_swap_b32 v242, v246
    v_permlane32_swap_b32 v243, v247
    v_add_f32_dpp v240, v244, v240 row_ror:8 row_mask:0xf bank_mask:0xf
    v_add_f32_dpp v241, v245, v241 row_ror:8 row_mask:0xf bank_mask:0xf
    v_add_f32_dpp v242, v246, v242 row_ror:8 row_mask:0xf bank_mask:0xf
    v_add_f32_dpp v243, v247, v243 row_ror:8 row_mask:0xf bank_mask:0xf
    v_perm_b32 v40, v240, v7, s4
    v_perm_b32 v41, v241, v7, s5
    v_perm_b32 v42, v242, v7, s6
    v_perm_b32 v43, v243, v7, s7
    s_mov_b32 exec_hi, 0
    s_mov_b32 exec_lo, s21
    buffer_store_dwordx4 v[40:43], v226, s[60:63], s19 offen
    s_mov_b32 exec_lo, 0x00ff00ff
    ds_write_b128 v253, v[240:243]
    s_mov_b64 exec, -1
    buffer_load_dword v18, v227, s[60:63], s16 offen sc1
    buffer_load_dword v19, v227, s[60:63], s16 offen offset:128 sc1
    s_lshl_b32 s39, s46, 9
    s_add_u32 s39, s39, s38
    s_mov_b32 s68, 0
    s_waitcnt lgkmcnt(0)
    s_barrier
    ds_read2st64_b32 v[16:17], v254 offset0:0 offset1:1
    v_mov_b32 v12, 0xc0135761
L_ex:
    s_waitcnt vmcnt(1)
    v_xor_b32 v18, v9, v18
    s_waitcnt vmcnt(0)
    v_xor_b32 v19, v9, v19
    v_or_b32 v10, v18, v19
    v_and_b32 v10, 0xff, v10
    v_cmp_ne_u32 vcc, 0, v10
    s_cbranch_vccnz L_ex_r
L_ex_ok:
    s_waitcnt lgkmcnt(0)
    v_pk_add_f32 v[16:17], v[16:17], v[18:19]
    v_add_f32 v16, v16, v17
    v_mov_b32 v10, v16
    s_nop 1
    v_permlane32_swap_b32 v10, v16
    v_add_f32 v16, v16, v10
    v_add_f32 v16, v16, v255
    v_mul_f32 v10, v16, v16
    v_fmac_f32 v12, 0xbdd2d3e8, v10
    v_mul_f32 v12, v12, v16
    v_exp_f32 v12, v12
    s_nop 0
    v_add_f32 v12, 1.0, v12
    v_rcp_f32 v12, v12
    s_nop 0
    v_mul_f32 v16, v16, v12
    v_cvt_pk_bf16_f32 v16, v16, v16
    s_nop 1
    v_mov_b32_dpp v16, v16 row_ror:8 row_mask:0xc bank_mask:0xf
    s_cmp_eq_u32 s46, 3
    s_cbranch_scc1 L_f2_two
    v_and_b32_dpp v244, v16, v232 row_newbcast:0 row_mask:0xf bank_mask:0xf
    v_and_b32_dpp v245, v16, v233 row_newbcast:0 row_mask:0xf bank_mask:0xf
    v_and_b32_dpp v246, v16, v234 row_newbcast:0 row_mask:0xf bank_mask:0xf
    v_and_b32_dpp v247, v16, v235 row_newbcast:0 row_mask:0xf bank_mask:0xf
    v_and_b32_dpp v248, v16, v232 row_newbcast:1 row_mask:0xf bank_mask:0xf
    v_and_b32_dpp v249, v16, v233 row_newbcast:1 row_mask:0xf bank_mask:0xf
    v_and_b32_dpp v250, v16, v234 row_newbcast:1 row_mask:0xf bank_mask:0xf
    v_and_b32_dpp v251, v16, v235 row_newbcast:1 row_mask:0xf bank_mask:0xf
    v_mfma_f32_16x16x32_bf16 v[236:239], v[244:247], v[108:111], 0
    v_and_b32_dpp v244, v16, v232 row_newbcast:2 row_mask:0xf bank_mask:0xf
    v_and_b32_dpp v245, v16, v233 row_newbcast:2 row_mask:0xf bank_mask:0xf
    v_and_b32_dpp v246, v16, v234 row_newbcast:2 row_mask:0xf bank_mask:0xf
    v_and_b32_dpp v247, v16, v235 row_newbcast:2 row_mask:0xf bank_mask:0xf
    v_mfma_f32_16x16x32_bf16 v[236:239], v[248:251], v[112:115], v[236:239]
    v_and_b32_dpp v248, v16, v232 row_newbcast:3 row_mask:0xf bank_mask:0xf
    v_and_b32_dpp v249, v16, v233 row_newbcast:3 row_mask:0xf bank_mask:0xf
    v_and_b32_dpp v250, v16, v234 row_newbcast:3 row_mask:0xf bank_mask:0xf
    v_and_b32_dpp v251, v16, v235 row_newbcast:3 row_mask:0xf bank_mask:0xf
    v_mfma_f32_16x16x32_bf16 v[236:239], v[244:247], v[116:119], v[236:239]
    v_and_b32_dpp v244, v16, v232 row_newbcast:4 row_mask:0xf bank_mask:0xf
    v_and_b32_dpp v245, v16, v233 row_newbcast:4 row_mask:0xf bank_mask:0xf
    v_and_b32_dpp v246, v16, v234 row_newbcast:4 row_mask:0xf bank_mask:0xf
    v_and_b32_dpp v247, v16, v235 row_newbcast:4 row_mask:0xf bank_mask:0xf
    v_mfma_f32_16x16x32_bf16 v[236:239], v[248:251], v[120:123], v[236:239]
    v_and_b32_dpp v248, v16, v232 row_newbcast:5 row_mask:0xf bank_mask:0xf
    v_and_b32_dpp v249, v16, v233 row_newbcast:5 row_mask:0xf bank_mask:0xf
    v_and_b32_dpp v250, v16, v234 row_newbcast:5 row_mask:0xf bank_mask:0xf
    v_and_b32_dpp v251, v16, v235 row_newbcast:5 row_mask:0xf bank_mask:0xf
    v_mfma_f32_16x16x32_bf16 v[236:239], v[244:247], v[124:127], v[236:239]
    v_and_b32_dpp v244, v16, v232 row_newbcast:6 row_mask:0xf bank_mask:0xf
    v_and_b32_dpp v245, v16, v233 row_newbcast:6 row_mask:0xf bank_mask:0xf
    v_and_b32_dpp v246, v16, v234 row_newbcast:6 row_mask:0xf bank_mask:0xf
    v_and_b32_dpp v247, v16, v235 row_newbcast:6 row_mask:0xf bank_mask:0xf
    v_mfma_f32_16x16x32_bf16 v[236:239], v[248:251], v[128:131], v[236:239]
    v_and_b32_dpp v248, v16, v232 row_newbcast:7 row_mask:0xf bank_mask:0xf
    v_and_b32_dpp v249, v16, v233 row_newbcast:7 row_mask:0xf bank_mask:0xf
    v_and_b32_dpp v250, v16, v234 row_newbcast:7 row_mask:0xf bank_mask:0xf
    v_and_b32_dpp v251, v16, v235 row_newbcast:7 row_mask:0xf bank_mask:0xf
    v_mfma_f32_16x16x32_bf16 v[236:239], v[244:247], v[132:135], v[236:239]
    s_nop 0
    v_mfma_f32_16x16x32_bf16 v[236:239], v[248:251], v[136:139], v[236:239]
    s_nop 7
    v_perm_b32 v236, v236, v7, s4
    v_perm_b32 v237, v237, v7, s5
    v_perm_b32 v238, v238, v7, s6
    v_perm_b32 v239, v239, v7, s7
    s_mov_b32 exec_hi, 0
    buffer_store_dwordx4 v[236:239], v8, s[60:63], s39 offen sc1
    s_mov_b32 exec_hi, 0
    s_mov_b32 exec_lo, s21
    buffer_store_dwordx4 v[40:43], v226, s[60:63], s19 offen sc1
    s_endpgm
L_f2_two:
    v_and_b32_dpp v244, v16, v232 row_newbcast:0 row_mask:0xf bank_mask:0xf
    v_and_b32_dpp v245, v16, v233 row_newbcast:0 row_mask:0xf bank_mask:0xf
    v_and_b32_dpp v246, v16, v234 row_newbcast:0 row_mask:0xf bank_mask:0xf
    v_and_b32_dpp v247, v16, v235 row_newbcast:0 row_mask:0xf bank_mask:0xf
    v_and_b32_dpp v248, v16, v232 row_newbcast:1 row_mask:0xf bank_mask:0xf
    v_and_b32_dpp v249, v16, v233 row_newbcast:1 row_mask:0xf bank_mask:0xf
    v_and_b32_dpp v250, v16, v234 row_newbcast:1 row_mask:0xf bank_mask:0xf
    v_and_b32_dpp v251, v16, v235 row_newbcast:1 row_mask:0xf bank_mask:0xf
    v_mfma_f32_16x16x32_bf16 v[236:239], v[244:247], v[108:111], 0
    v_mfma_f32_16x16x32_bf16 v[240:243], v[244:247], v[140:143], 0
    v_and_b32_dpp v244, v16, v232 row_newbcast:2 row_mask:0xf bank_mask:0xf
    v_and_b32_dpp v245, v16, v233 row_newbcast:2 row_mask:0xf bank_mask:0xf
    v_and_b32_dpp v246, v16, v234 row_newbcast:2 row_mask:0xf bank_mask:0xf
    v_and_b32_dpp v247, v16, v235 row_newbcast:2 row_mask:0xf bank_mask:0xf
    v_mfma_f32_16x16x32_bf16 v[236:239], v[248:251], v[112:115], v[236:239]
    v_mfma_f32_16x16x32_bf16 v[240:243], v[248:251], v[144:147], v[240:243]
    v_and_b32_dpp v248, v16, v232 row_newbcast:3 row_mask:0xf bank_mask:0xf
    v_and_b32_dpp v249, v16, v233 row_newbcast:3 row_mask:0xf bank_mask:0xf
    v_and_b32_dpp v250, v16, v234 row_newbcast:3 row_mask:0xf bank_mask:0xf
    v_and_b32_dpp v251, v16, v235 row_newbcast:3 row_mask:0xf bank_mask:0xf
    v_mfma_f32_16x16x32_bf16 v[236:239], v[244:247], v[116:119], v[236:239]
    v_mfma_f32_16x16x32_bf16 v[240:243], v[244:247], v[148:151], v[240:243]
    v_and_b32_dpp v244, v16, v232 row_newbcast:4 row_mask:0xf bank_mask:0xf
    v_and_b32_dpp v245, v16, v233 row_newbcast:4 row_mask:0xf bank_mask:0xf
    v_and_b32_dpp v246, v16, v234 row_newbcast:4 row_mask:0xf bank_mask:0xf
    v_and_b32_dpp v247, v16, v235 row_newbcast:4 row_mask:0xf bank_mask:0xf
    v_mfma_f32_16x16x32_bf16 v[236:239], v[248:251], v[120:123], v[236:239]
    v_mfma_f32_16x16x32_bf16 v[240:243], v[248:251], v[152:155], v[240:243]
    v_and_b32_dpp v248, v16, v232 row_newbcast:5 row_mask:0xf bank_mask:0xf
    v_and_b32_dpp v249, v16, v233 row_newbcast:5 row_mask:0xf bank_mask:0xf
    v_and_b32_dpp v250, v16, v234 row_newbcast:5 row_mask:0xf bank_mask:0xf
    v_and_b32_dpp v251, v16, v235 row_newbcast:5 row_mask:0xf bank_mask:0xf
    v_mfma_f32_16x16x32_bf16 v[236:239], v[244:247], v[124:127], v[236:239]
    v_mfma_f32_16x16x32_bf16 v[240:243], v[244:247], v[156:159], v[240:243]
    v_and_b32_dpp v244, v16, v232 row_newbcast:6 row_mask:0xf bank_mask:0xf
    v_and_b32_dpp v245, v16, v233 row_newbcast:6 row_mask:0xf bank_mask:0xf
    v_and_b32_dpp v246, v16, v234 row_newbcast:6 row_mask:0xf bank_mask:0xf
    v_and_b32_dpp v247, v16, v235 row_newbcast:6 row_mask:0xf bank_mask:0xf
    v_mfma_f32_16x16x32_bf16 v[236:239], v[248:251], v[128:131], v[236:239]
    v_mfma_f32_16x16x32_bf16 v[240:243], v[248:251], v[160:163], v[240:243]
    v_and_b32_dpp v248, v16, v232 row_newbcast:7 row_mask:0xf bank_mask:0xf
    v_and_b32_dpp v249, v16, v233 row_newbcast:7 row_mask:0xf bank_mask:0xf
    v_and_b32_dpp v250, v16, v234 row_newbcast:7 row_mask:0xf bank_mask:0xf
    v_and_b32_dpp v251, v16, v235 row_newbcast:7 row_mask:0xf bank_mask:0xf
    v_mfma_f32_16x16x32_bf16 v[236:239], v[244:247], v[132:135], v[236:239]
    v_mfma_f32_16x16x32_bf16 v[240:243], v[244:247], v[164:167], v[240:243]
    v_mfma_f32_16x16x32_bf16 v[236:239], v[248:251], v[136:139], v[236:239]
    v_mfma_f32_16x16x32_bf16 v[240:243], v[248:251], v[168:171], v[240:243]
    s_nop 6
    v_perm_b32 v236, v236, v7, s4
    v_perm_b32 v237, v237, v7, s5
    v_perm_b32 v238, v238, v7, s6
    v_perm_b32 v239, v239, v7, s7
    v_perm_b32 v240, v240, v7, s4
    v_perm_b32 v241, v241, v7, s5
    v_perm_b32 v242, v242, v7, s6
    v_perm_b32 v243, v243, v7, s7
    s_mov_b32 exec_hi, 0
    buffer_store_dwordx4 v[236:239], v8, s[60:63], s39 offen sc1
    s_mov_b32 exec_lo, 0x00ff00ff
    buffer_store_dwordx4 v[240:243], v8, s[60:63], s38 offen offset:2048 sc1
    s_mov_b32 exec_hi, 0
    s_mov_b32 exec_lo, s21
    buffer_store_dwordx4 v[40:43], v226, s[60:63], s19 offen sc1
    s_endpgm
L_wq1:
    s_waitcnt vmcnt(4)
    buffer_load_dwordx4 v[36:39], v5, s[52:55], s69 offen nt
    s_add_u32 s69, s69, 32768
    s_waitcnt vmcnt(4)
    buffer_load_dwordx4 v[40:43], v5, s[52:55], s69 offen nt
    s_add_u32 s69, s69, 32768
    s_waitcnt vmcnt(4)
    buffer_load_dwordx4 v[44:47], v5, s[52:55], s69 offen nt
    s_add_u32 s69, s69, 32768
    s_waitcnt vmcnt(4)
    buffer_load_dwordx4 v[48:51], v5, s[52:55], s69 offen nt
    s_add_u32 s69, s69, 32768
    s_waitcnt vmcnt(4)
    buffer_load_dwordx4 v[52:55], v5, s[52:55], s69 offen nt
    s_add_u32 s69, s69, 32768
    s_waitcnt vmcnt(4)
    buffer_load_dwordx4 v[56:59], v5, s[52:55], s69 offen nt
    s_add_u32 s69, s69, 32768
    v_mov_b32 v6, 1
    v_mov_b32 v7, 3336
    ds_write_b32 v7, v6
    s_waitcnt vmcnt(4)
    buffer_load_dwordx4 v[60:63], v5, s[52:55], s69 offen nt
    s_add_u32 s69, s69, 32768
    s_waitcnt vmcnt(4)
    buffer_load_dwordx4 v[64:67], v5, s[52:55], s69 offen nt
    s_add_u32 s69, s69, 32768
    s_waitcnt vmcnt(4)
    buffer_load_dwordx4 v[68:71], v5, s[52:55], s69 offen nt
    s_add_u32 s69, s69, 32768
    s_waitcnt vmcnt(4)
    buffer_load_dwordx4 v[72:75], v5, s[52:55], s69 offen nt
    s_add_u32 s69, s69, 32768
    s_waitcnt vmcnt(4)
    buffer_load_dwordx4 v[76:79], v5, s[52:55], s69 offen nt
    s_add_u32 s69, s69, 32768
    s_waitcnt vmcnt(4)
    buffer_load_dwordx4 v[80:83], v5, s[52:55], s69 offen nt
    s_add_u32 s69, s69, 32768
    s_waitcnt vmcnt(4)
    buffer_load_dwordx4 v[84:87], v5, s[52:55], s69 offen nt
    s_waitcnt lgkmcnt(0)
    s_add_u32 s43, s43, 0x01010101
    s_mov_b32 s4, 0x07060500
    s_bfe_u32 s92, s43, 0x80000
    s_mov_b32 s5, 0x07060501
    s_bfe_u32 s93, s43, 0x80008
    s_mov_b32 s6, 0x07060502
    s_bfe_u32 s94, s43, 0x80010
    s_mov_b32 s7, 0x07060503
    s_bfe_u32 s95, s43, 0x80018
    v_mov_b32 v196, s43
    v_bfe_u32 v13, v0, 3, 1
    v_mul_u32_u24 v13, 0x202, v13
    v_add_u32 v13, 0x100, v13
    v_and_b32 v14, 1, v0
    v_lshlrev_b32 v14, 4, v14
    v_lshlrev_b32 v13, v14, v13
    v_mov_b32 v15, 0x0c0c0000
    v_lshrrev_b32 v14, v14, v15
    v_or_b32 v13, v13, v14
    v_bfe_u32 v14, v0, 1, 2
    v_mov_b32 v15, 0x0c0c0c0c
    v_cmp_eq_u32 vcc, 0, v14
    s_nop 1
    v_cndmask_b32 v192, v15, v13, vcc
    v_cmp_eq_u32 vcc, 1, v14
    s_nop 1
    v_cndmask_b32 v193, v15, v13, vcc
    v_cmp_eq_u32 vcc, 2, v14
    s_nop 1
    v_cndmask_b32 v194, v15, v13, vcc
    v_cmp_eq_u32 vcc, 3, v14
    s_nop 1
    v_cndmask_b32 v195, v15, v13, vcc
    v_lshlrev_b32 v197, 3, v2
    v_lshrrev_b32 v197, v197, v196
    v_and_b32 v197, 0xff, v197
    v_lshlrev_b32 v251, 2, v8
    s_lshl_b32 s69, s41, 3
    s_add_u32 s69, s69, s42
    s_lshl_b32 s69, s69, 12
    s_lshl_b32 s38, s40, 9
    s_add_u32 s69, s69, s38
    s_add_u32 s69, s69, 665600
    v_lshrrev_b32 v14, 1, v2
    v_lshlrev_b32 v14, 11, v14
    v_lshl_add_u32 v14, v1, 5, v14
    v_and_b32 v15, 1, v2
    v_lshl_add_u32 v14, v15, 4, v14
    v_lshlrev_b32 v13, 2, v2
    v_add_u32 v13, 512, v13
    s_mov_b32 s76, 0
    s_mov_b32 s77, -1
    s_setprio 2
    v_mov_b32 v9, 3328
    s_mov_b32 s68, 0
L_hf:
    ds_read_b32 v10, v9
    s_waitcnt lgkmcnt(0)
    v_cmp_le_u32 vcc, 1, v10
    s_cbranch_vccnz L_hf_ok
    s_sleep 1
    s_add_u32 s68, s68, 1
    s_cmp_lt_u32 s68, 320000
    s_cbranch_scc1 L_hf
L_hf_ok:
    ds_read2_b32 v[160:161], v13 offset0:0 offset1:4
    ds_read2_b32 v[162:163], v13 offset0:8 offset1:12
    ds_read2_b32 v[164:165], v13 offset0:16 offset1:20
    ds_read2_b32 v[166:167], v13 offset0:24 offset1:28
    ds_read2_b32 v[168:169], v13 offset0:32 offset1:36
    ds_read2_b32 v[170:171], v13 offset0:40 offset1:44
    ds_read2_b32 v[172:173], v13 offset0:48 offset1:52
    ds_read2_b32 v[174:175], v13 offset0:56 offset1:60
    ds_read2_b32 v[176:177], v13 offset0:64 offset1:68
    ds_read_b32 v9, v9 offset:4
    s_waitcnt lgkmcnt(0)
    v_readfirstlane_b32 s75, v9
    v_perm_b32 v180, v160, v160, v192
    v_perm_b32 v181, v160, v160, v193
    v_perm_b32 v182, v160, v160, v194
    v_perm_b32 v183, v160, v160, v195
    v_perm_b32 v184, v161, v161, v192
    v_perm_b32 v185, v161, v161, v193
    v_perm_b32 v186, v161, v161, v194
    v_perm_b32 v187, v161, v161, v195
    s_waitcnt vmcnt(15)
    v_mfma_f32_16x16x32_bf16 v[188:191], v[180:183], v[16:19], 0
    v_perm_b32 v180, v162, v162, v192
    v_perm_b32 v181, v162, v162, v193
    v_perm_b32 v182, v162, v162, v194
    v_perm_b32 v183, v162, v162, v195
    v_mfma_f32_16x16x32_bf16 v[188:191], v[184:187], v[20:23], v[188:191]
    v_perm_b32 v184, v163, v163, v192
    v_perm_b32 v185, v163, v163, v193
    v_perm_b32 v186, v163, v163, v194
    v_perm_b32 v187, v163, v163, v195
    v_mfma_f32_16x16x32_bf16 v[188:191], v[180:183], v[24:27], v[188:191]
    v_perm_b32 v180, v164, v164, v192
    v_perm_b32 v181, v164, v164, v193
    v_perm_b32 v182, v164, v164, v194
    v_perm_b32 v183, v164, v164, v195
    s_waitcnt vmcnt(12)
    v_mfma_f32_16x16x32_bf16 v[188:191], v[184:187], v[28:31], v[188:191]
    v_perm_b32 v184, v165, v165, v192
    v_perm_b32 v185, v165, v165, v193
    v_perm_b32 v186, v165, v165, v194
    v_perm_b32 v187, v165, v165, v195
    v_mfma_f32_16x16x32_bf16 v[188:191], v[180:183], v[32:35], v[188:191]
    v_perm_b32 v180, v166, v166, v192
    v_perm_b32 v181, v166, v166, v193
    v_perm_b32 v182, v166, v166, v194
    v_perm_b32 v183, v166, v166, v195
    v_mfma_f32_16x16x32_bf16 v[188:191], v[184:187], v[36:39], v[188:191]
    v_perm_b32 v184, v167, v167, v192
    v_perm_b32 v185, v167, v167, v193
    v_perm_b32 v186, v167, v167, v194
    v_perm_b32 v187, v167, v167, v195
    s_waitcnt vmcnt(9)
    v_mfma_f32_16x16x32_bf16 v[188:191], v[180:183], v[40:43], v[188:191]
    v_perm_b32 v180, v168, v168, v192
    v_perm_b32 v181, v168, v168, v193
    v_perm_b32 v182, v168, v168, v194
    v_perm_b32 v183, v168, v168, v195
    v_mfma_f32_16x16x32_bf16 v[188:191], v[184:187], v[44:47], v[188:191]
    v_perm_b32 v184, v169, v169, v192
    v_perm_b32 v185, v169, v169, v193
    v_perm_b32 v186, v169, v169, v194
    v_perm_b32 v187, v169, v169, v195
    v_mfma_f32_16x16x32_bf16 v[188:191], v[180:183], v[48:51], v[188:191]
    v_perm_b32 v180, v170, v170, v192
    v_perm_b32 v181, v170, v170, v193
    v_perm_b32 v182, v170, v170, v194
    v_perm_b32 v183, v170, v170, v195
    s_waitcnt vmcnt(6)
    v_mfma_f32_16x16x32_bf16 v[188:191], v[184:187], v[52:55], v[188:191]
    v_perm_b32 v184, v171, v171, v192
    v_perm_b32 v185, v171, v171, v193
    v_perm_b32 v186, v171, v171, v194
    v_perm_b32 v187, v171, v171, v195
    v_mfma_f32_16x16x32_bf16 v[188:191], v[180:183], v[56:59], v[188:191]
    v_perm_b32 v180, v172, v172, v192
    v_perm_b32 v181, v172, v172, v193
    v_perm_b32 v182, v172, v172, v194
    v_perm_b32 v183, v172, v172, v195
    v_mfma_f32_16x16x32_bf16 v[188:191], v[184:187], v[60:63], v[188:191]
    v_perm_b32 v184, v173, v173, v192
    v_perm_b32 v185, v173, v173, v193
    v_perm_b32 v186, v173, v173, v194
    v_perm_b32 v187, v173, v173, v195
    s_waitcnt vmcnt(3)
    v_mfma_f32_16x16x32_bf16 v[188:191], v[180:183], v[64:67], v[188:191]
    v_perm_b32 v180, v174, v174, v192
    v_perm_b32 v181, v174, v174, v193
    v_perm_b32 v182, v174, v174, v194
    v_perm_b32 v183, v174, v174, v195
    v_mfma_f32_16x16x32_bf16 v[188:191], v[184:187], v[68:71], v[188:191]
    v_perm_b32 v184, v175, v175, v192
    v_perm_b32 v185, v175, v175, v193
    v_perm_b32 v186, v175, v175, v194
    v_perm_b32 v187, v175, v175, v195
    v_mfma_f32_16x16x32_bf16 v[188:191], v[180:183], v[72:75], v[188:191]
    v_perm_b32 v180, v176, v176, v192
    v_perm_b32 v181, v176, v176, v193
    v_perm_b32 v182, v176, v176, v194
    v_perm_b32 v183, v176, v176, v195
    s_waitcnt vmcnt(0)
    v_mfma_f32_16x16x32_bf16 v[188:191], v[184:187], v[76:79], v[188:191]
    v_perm_b32 v184, v177, v177, v192
    v_perm_b32 v185, v177, v177, v193
    v_perm_b32 v186, v177, v177, v194
    v_perm_b32 v187, v177, v177, v195
    v_mfma_f32_16x16x32_bf16 v[188:191], v[180:183], v[80:83], v[188:191]
    s_nop 0
    v_mfma_f32_16x16x32_bf16 v[188:191], v[184:187], v[84:87], v[188:191]
    s_nop 7
    v_and_b32 v184, 0xffffff00, v188
    v_and_b32 v185, 0xffffff00, v189
    v_and_b32 v186, 0xffffff00, v190
    v_and_b32 v187, 0xffffff00, v191
    v_cndmask_b32 v184, 0, v184, s[76:77]
    v_cndmask_b32 v185, 0, v185, s[76:77]
    v_cndmask_b32 v186, 0, v186, s[76:77]
    v_cndmask_b32 v187, 0, v187, s[76:77]
    v_sub_f32 v188, v188, v184
    v_sub_f32 v189, v189, v185
    v_sub_f32 v190, v190, v186
    v_sub_f32 v191, v191, v187
    v_perm_b32 v188, v188, v196, s4
    v_perm_b32 v189, v189, v196, s5
    v_perm_b32 v190, v190, v196, s6
    v_perm_b32 v191, v191, v196, s7
    s_cmp_lg_u32 s75, 0
    s_cbranch_scc0 L_w_qslow
    buffer_store_dwordx4 v[188:191], v14, s[60:63], s69 offen
L_w_qst:
    v_mov_b32 v9, 3340
    v_mov_b32 v10, 1
    s_mov_b64 exec, 1
    ds_add_u32 v9, v10
    s_mov_b64 exec, -1
    s_setprio 0
    s_branch L_w_wo
L_wo1:
    s_waitcnt lgkmcnt(0)
    s_add_u32 s43, s43, 0x01010101
    s_mov_b32 s4, 0x07060500
    s_bfe_u32 s92, s43, 0x80000
    s_mov_b32 s5, 0x07060501
    s_bfe_u32 s93, s43, 0x80008
    s_mov_b32 s6, 0x07060502
    s_bfe_u32 s94, s43, 0x80010
    s_mov_b32 s7, 0x07060503
    s_bfe_u32 s95, s43, 0x80018
    v_mov_b32 v196, s43
    v_bfe_u32 v13, v0, 3, 1
    v_mul_u32_u24 v13, 0x202, v13
    v_add_u32 v13, 0x100, v13
    v_and_b32 v14, 1, v0
    v_lshlrev_b32 v14, 4, v14
    v_lshlrev_b32 v13, v14, v13
    v_mov_b32 v15, 0x0c0c0000
    v_lshrrev_b32 v14, v14, v15
    v_or_b32 v13, v13, v14
    v_bfe_u32 v14, v0, 1, 2
    v_mov_b32 v15, 0x0c0c0c0c
    v_cmp_eq_u32 vcc, 0, v14
    s_nop 1
    v_cndmask_b32 v192, v15, v13, vcc
    v_cmp_eq_u32 vcc, 1, v14
    s_nop 1
    v_cndmask_b32 v193, v15, v13, vcc
    v_cmp_eq_u32 vcc, 2, v14
    s_nop 1
    v_cndmask_b32 v194, v15, v13, vcc
    v_cmp_eq_u32 vcc, 3, v14
    s_nop 1
    v_cndmask_b32 v195, v15, v13, vcc
    v_lshlrev_b32 v197, 3, v2
    v_lshrrev_b32 v197, v197, v196
    v_and_b32 v197, 0xff, v197
    v_lshlrev_b32 v251, 2, v8
    s_cmp_eq_u32 s40, 5
    s_cbranch_scc1 L_w_ln
    s_cmp_eq_u32 s40, 4
    s_cbranch_scc0 L_w_67
    s_setprio 3
    s_getreg_b32 s38, hwreg(HW_REG_XCC_ID, 0, 4)
    s_lshl_b32 s38, s38, 8
    v_mov_b32 v200, s38
    v_mov_b32 v201, 0
    v_mov_b32 v202, 0
    v_mov_b32 v203, 0
    v_perm_b32 v200, v200, v196, s4
    v_perm_b32 v201, v201, v196, s5
    v_perm_b32 v202, v202, v196, s6
    v_perm_b32 v203, v203, v196, s7
    s_lshl_b32 s38, s41, 4
    s_add_u32 s38, s38, s42
    s_lshl_b32 s38, s38, 7
    s_add_u32 s38, s38, 933888
    v_lshlrev_b32 v13, 4, v0
    s_mov_b64 exec, 0xff
    buffer_store_dwordx4 v[200:203], v13, s[60:63], s38 offen sc1
    s_mov_b64 exec, -1
    v_lshl_add_u32 v13, v0, 1, 0
    v_lshl_add_u32 v14, v2, 2, 0
    s_mul_i32 s70, s46, 13824
    s_lshl_b32 s39, s45, 8
    s_add_u32 s70, s70, s39
    s_add_u32 s70, s70, 4096
    s_mul_i32 s72, s46, 4608
    s_add_u32 s72, s39, s72
    s_add_u32 s72, s72, 59392
    s_waitcnt vmcnt(19)
    v_lshlrev_b32 v10, 16, v10
    v_lshlrev_b32 v11, 16, v11
    v_lshlrev_b32 v12, 16, v12
    s_mov_b32 s38, 0xbfb8aa3b
    v_mul_f32 v160, s38, v10
    v_mul_f32 v161, s38, v11
    v_mul_f32 v162, s38, v12
    v_fma_f32 v163, v10, s38, -v160
    v_fma_f32 v164, v11, s38, -v161
    v_fma_f32 v165, v12, s38, -v162
    v_exp_f32 v160, v160
    v_exp_f32 v161, v161
    v_exp_f32 v162, v162
    v_fmac_f32 v163, 0xb2a57060, v10
    v_fmac_f32 v164, 0xb2a57060, v11
    v_fmac_f32 v165, 0xb2a57060, v12
    v_mul_f32 v163, 0x3f317218, v163
    v_mul_f32 v164, 0x3f317218, v164
    v_mul_f32 v165, 0x3f317218, v165
    v_min_f32 v160, 0x7e800000, v160
    v_min_f32 v161, 0x7e800000, v161
    v_min_f32 v162, 0x7e800000, v162
    v_fmac_f32 v160, v163, v160
    v_fmac_f32 v161, v164, v161
    v_fmac_f32 v162, v165, v162
    v_add_f32 v160, 1.0, v160
    v_add_f32 v161, 1.0, v161
    v_add_f32 v162, 1.0, v162
    v_rcp_f32 v163, v160
    v_rcp_f32 v164, v161
    v_rcp_f32 v165, v162
    v_mul_f32 v166, v10, v163
    v_mul_f32 v167, v11, v164
    v_mul_f32 v168, v12, v165
    v_fma_f32 v10, -v166, v160, v10
    v_fma_f32 v11, -v167, v161, v11
    v_fma_f32 v12, -v168, v162, v12
    v_fma_f32 v10, v10, v163, v166
    v_fma_f32 v11, v11, v164, v167
    v_fma_f32 v12, v12, v165, v168
    v_cvt_pk_bf16_f32 v160, v10, v11
    v_cvt_pk_bf16_f32 v161, v12, v12
    ds_write_b16 v13, v160
    ds_write_b16_d16_hi v13, v160 offset:128
    ds_write_b16 v13, v161 offset:256
    ds_read2_b32 v[160:161], v14 offset0:0 offset1:4
    ds_read2_b32 v[162:163], v14 offset0:8 offset1:12
    ds_read2_b32 v[164:165], v14 offset0:16 offset1:20
    ds_read2_b32 v[166:167], v14 offset0:24 offset1:28
    ds_read2_b32 v[168:169], v14 offset0:32 offset1:36
    ds_read2_b32 v[170:171], v14 offset0:40 offset1:44
    ds_read2_b32 v[172:173], v14 offset0:48 offset1:52
    ds_read2_b32 v[174:175], v14 offset0:56 offset1:60
    ds_read2_b32 v[176:177], v14 offset0:64 offset1:68
    v_lshlrev_b32 v13, 5, v1
    v_lshl_add_u32 v13, v2, 4, v13
    s_waitcnt lgkmcnt(0)
    v_perm_b32 v180, v160, v160, v192
    v_perm_b32 v181, v160, v160, v193
    v_perm_b32 v182, v160, v160, v194
    v_perm_b32 v183, v160, v160, v195
    v_perm_b32 v184, v161, v161, v192
    v_perm_b32 v185, v161, v161, v193
    v_perm_b32 v186, v161, v161, v194
    v_perm_b32 v187, v161, v161, v195
    s_waitcnt vmcnt(16)
    v_mfma_f32_16x16x32_bf16 v[188:191], v[180:183], v[16:19], 0
    v_perm_b32 v180, v162, v162, v192
    v_perm_b32 v181, v162, v162, v193
    v_perm_b32 v182, v162, v162, v194
    v_perm_b32 v183, v162, v162, v195
    v_mfma_f32_16x16x32_bf16 v[188:191], v[184:187], v[20:23], v[188:191]
    v_perm_b32 v184, v163, v163, v192
    v_perm_b32 v185, v163, v163, v193
    v_perm_b32 v186, v163, v163, v194
    v_perm_b32 v187, v163, v163, v195
    v_mfma_f32_16x16x32_bf16 v[188:191], v[180:183], v[24:27], v[188:191]
    v_perm_b32 v180, v164, v164, v192
    v_perm_b32 v181, v164, v164, v193
    v_perm_b32 v182, v164, v164, v194
    v_perm_b32 v183, v164, v164, v195
    s_waitcnt vmcnt(13)
    v_mfma_f32_16x16x32_bf16 v[188:191], v[184:187], v[28:31], v[188:191]
    v_perm_b32 v184, v165, v165, v192
    v_perm_b32 v185, v165, v165, v193
    v_perm_b32 v186, v165, v165, v194
    v_perm_b32 v187, v165, v165, v195
    v_mfma_f32_16x16x32_bf16 v[188:191], v[180:183], v[32:35], v[188:191]
    v_perm_b32 v180, v166, v166, v192
    v_perm_b32 v181, v166, v166, v193
    v_perm_b32 v182, v166, v166, v194
    v_perm_b32 v183, v166, v166, v195
    v_mfma_f32_16x16x32_bf16 v[188:191], v[184:187], v[36:39], v[188:191]
    v_perm_b32 v184, v167, v167, v192
    v_perm_b32 v185, v167, v167, v193
    v_perm_b32 v186, v167, v167, v194
    v_perm_b32 v187, v167, v167, v195
    s_waitcnt vmcnt(10)
    v_mfma_f32_16x16x32_bf16 v[188:191], v[180:183], v[40:43], v[188:191]
    v_perm_b32 v180, v168, v168, v192
    v_perm_b32 v181, v168, v168, v193
    v_perm_b32 v182, v168, v168, v194
    v_perm_b32 v183, v168, v168, v195
    v_mfma_f32_16x16x32_bf16 v[188:191], v[184:187], v[44:47], v[188:191]
    v_perm_b32 v184, v169, v169, v192
    v_perm_b32 v185, v169, v169, v193
    v_perm_b32 v186, v169, v169, v194
    v_perm_b32 v187, v169, v169, v195
    v_mfma_f32_16x16x32_bf16 v[188:191], v[180:183], v[48:51], v[188:191]
    v_perm_b32 v180, v170, v170, v192
    v_perm_b32 v181, v170, v170, v193
    v_perm_b32 v182, v170, v170, v194
    v_perm_b32 v183, v170, v170, v195
    s_waitcnt vmcnt(7)
    v_mfma_f32_16x16x32_bf16 v[188:191], v[184:187], v[52:55], v[188:191]
    v_perm_b32 v184, v171, v171, v192
    v_perm_b32 v185, v171, v171, v193
    v_perm_b32 v186, v171, v171, v194
    v_perm_b32 v187, v171, v171, v195
    v_mfma_f32_16x16x32_bf16 v[188:191], v[180:183], v[56:59], v[188:191]
    v_perm_b32 v180, v172, v172, v192
    v_perm_b32 v181, v172, v172, v193
    v_perm_b32 v182, v172, v172, v194
    v_perm_b32 v183, v172, v172, v195
    v_mfma_f32_16x16x32_bf16 v[188:191], v[184:187], v[60:63], v[188:191]
    v_perm_b32 v184, v173, v173, v192
    v_perm_b32 v185, v173, v173, v193
    v_perm_b32 v186, v173, v173, v194
    v_perm_b32 v187, v173, v173, v195
    s_waitcnt vmcnt(4)
    v_mfma_f32_16x16x32_bf16 v[188:191], v[180:183], v[64:67], v[188:191]
    v_perm_b32 v180, v174, v174, v192
    v_perm_b32 v181, v174, v174, v193
    v_perm_b32 v182, v174, v174, v194
    v_perm_b32 v183, v174, v174, v195
    v_mfma_f32_16x16x32_bf16 v[188:191], v[184:187], v[68:71], v[188:191]
    v_perm_b32 v184, v175, v175, v192
    v_perm_b32 v185, v175, v175, v193
    v_perm_b32 v186, v175, v175, v194
    v_perm_b32 v187, v175, v175, v195
    v_mfma_f32_16x16x32_bf16 v[188:191], v[180:183], v[72:75], v[188:191]
    v_perm_b32 v180, v176, v176, v192
    v_perm_b32 v181, v176, v176, v193
    v_perm_b32 v182, v176, v176, v194
    v_perm_b32 v183, v176, v176, v195
    s_waitcnt vmcnt(1)
    v_mfma_f32_16x16x32_bf16 v[188:191], v[184:187], v[76:79], v[188:191]
    v_perm_b32 v184, v177, v177, v192
    v_perm_b32 v185, v177, v177, v193
    v_perm_b32 v186, v177, v177, v194
    v_perm_b32 v187, v177, v177, v195
    v_mfma_f32_16x16x32_bf16 v[188:191], v[180:183], v[80:83], v[188:191]
    s_nop 0
    v_mfma_f32_16x16x32_bf16 v[188:191], v[184:187], v[84:87], v[188:191]
    s_nop 7
    v_permlane32_swap_b32 v188, v180
    v_permlane32_swap_b32 v189, v181
    v_permlane32_swap_b32 v190, v182
    v_permlane32_swap_b32 v191, v183
    v_add_f32_dpp v188, v180, v188 row_ror:8 row_mask:0xf bank_mask:0xf
    v_add_f32_dpp v189, v181, v189 row_ror:8 row_mask:0xf bank_mask:0xf
    v_add_f32_dpp v190, v182, v190 row_ror:8 row_mask:0xf bank_mask:0xf
    v_add_f32_dpp v191, v183, v191 row_ror:8 row_mask:0xf bank_mask:0xf
    v_and_b32 v184, 0xffffff00, v188
    v_and_b32 v185, 0xffffff00, v189
    v_and_b32 v186, 0xffffff00, v190
    v_and_b32 v187, 0xffffff00, v191
    v_sub_f32 v184, v188, v184
    v_sub_f32 v185, v189, v185
    v_sub_f32 v186, v190, v186
    v_sub_f32 v187, v191, v187
    v_perm_b32 v188, v188, v196, s4
    v_perm_b32 v189, v189, v196, s5
    v_perm_b32 v190, v190, v196, s6
    v_perm_b32 v191, v191, v196, s7
    s_mov_b64 exec, s[78:79]
    buffer_store_dwordx4 v[188:191], v13, s[60:63], s70 offen sc1
    v_perm_b32 v184, v184, v196, s4
    v_perm_b32 v185, v185, v196, s5
    v_perm_b32 v186, v186, v196, s6
    v_perm_b32 v187, v187, v196, s7
    buffer_store_dwordx4 v[184:187], v13, s[60:63], s72 offen sc1
    s_mov_b64 exec, -1
    s_setprio 0
    s_cmp_lt_u32 s42, 8
    s_cbranch_scc0 L_w_m8
L_w_wo:
    v_mov_b32 v11, 3340
    s_mov_b32 s68, 0
L_qs:
    ds_read_b32 v14, v11
    s_waitcnt lgkmcnt(0)
    v_cmp_le_u32 vcc, 4, v14
    s_cbranch_vccnz L_qs_ok
    s_sleep 2
    s_add_u32 s68, s68, 1
    s_cmp_lt_u32 s68, 320000
    s_cbranch_scc1 L_qs
L_qs_ok:
    v_mul_u32_u24 v248, 1152, v2
    v_bfe_u32 v6, v0, 3, 1
    v_mul_u32_u24 v6, 36864, v6
    v_and_b32 v7, 7, v1
    v_lshl_add_u32 v6, v7, 4, v6
    v_add_u32 v248, v248, v6
    s_lshl_b32 s73, s41, 3
    s_add_u32 s73, s73, s40
    s_mul_i32 s73, s73, 73728
    s_lshl_b32 s39, s42, 7
    s_add_u32 s73, s73, s39
    s_mov_b32 s12, s16
    s_mov_b32 s13, s17
    s_mov_b32 s14, 4718592
    s_mov_b32 s15, 0x20000
    buffer_load_dwordx4 v[88:91], v248, s[12:15], s73 offen nt
    s_add_u32 s73, s73, 4608
    buffer_load_dwordx4 v[92:95], v248, s[12:15], s73 offen nt
    s_add_u32 s73, s73, 4608
    buffer_load_dwordx4 v[96:99], v248, s[12:15], s73 offen nt
    s_add_u32 s73, s73, 4608
    buffer_load_dwordx4 v[100:103], v248, s[12:15], s73 offen nt
    s_add_u32 s73, s73, 4608
    s_waitcnt vmcnt(3)
    buffer_load_dwordx4 v[104:107], v248, s[12:15], s73 offen nt
    s_add_u32 s73, s73, 4608
    s_waitcnt vmcnt(3)
    buffer_load_dwordx4 v[108:111], v248, s[12:15], s73 offen nt
    s_add_u32 s73, s73, 4608
    s_waitcnt vmcnt(3)
    buffer_load_dwordx4 v[112:115], v248, s[12:15], s73 offen nt
    s_add_u32 s73, s73, 4608
    s_waitcnt vmcnt(3)
    buffer_load_dwordx4 v[116:119], v248, s[12:15], s73 offen nt
L_w_wod:
    s_lshr_b32 s38, s40, 2
    s_lshl_b32 s39, s41, 1
    s_add_u32 s38, s38, s39
    s_mul_i32 s38, s38, 13824
    s_add_u32 s38, s38, 112640
    s_and_b32 s39, s40, 3
    s_lshl_b32 s70, s39, 8
    s_add_u32 s70, s70, s38
    s_lshr_b32 s39, s39, 1
    s_lshl_b32 s39, s39, 6
    s_add_u32 s71, s38, s39
    s_add_u32 s71, s71, 1024
    s_add_u32 s72, s70, 4608
    s_add_u32 s73, s70, 9216
    v_mul_u32_u24 v10, 1152, v2
    v_min_u32 v11, 2, v1
    v_mul_u32_u24 v11, 4608, v11
    v_add_u32 v11, v11, v10
    v_lshl_add_u32 v10, v1, 4, v10
    s_lshl_b32 s38, s40, 9
    s_add_u32 s38, s38, 8192
    v_and_b32 v14, 7, v1
    v_lshlrev_b32 v14, 5, v14
    v_and_b32 v15, 1, v2
    v_lshl_add_u32 v14, v15, 4, v14
    v_lshrrev_b32 v15, 1, v2
    v_lshl_add_u32 v14, v15, 8, v14
    v_add_u32 v249, s38, v14
    s_mov_b32 s79, 0xff00ff00
    v_lshlrev_b32 v250, 4, v0
    v_add_u32 v250, 8192, v250
    s_mul_i32 s69, s41, 2304
    s_lshl_b32 s39, s42, 8
    s_add_u32 s69, s69, s39
    s_mul_i32 s39, s40, 18432
    s_add_u32 s69, s69, s39
    s_add_u32 s69, s69, 2097152
    s_mov_b32 s76, 0x00070007
    s_mov_b32 s77, 0x00070007
    s_mov_b32 s74, 0xffffff00
    buffer_load_dwordx4 v[220:223], v10, s[60:63], s70 offen sc1
    buffer_load_dwordx4 v[224:227], v10, s[60:63], s72 offen sc1
    buffer_load_dwordx4 v[228:231], v10, s[60:63], s73 offen sc1
    s_waitcnt vmcnt(3)
    s_cmp_eq_u32 s42, 8
    s_cbranch_scc1 L_q_again
L_q_again_done:
    s_mov_b32 s68, 0
L_poll_7:
    buffer_load_dwordx4 v[244:247], v11, s[60:63], s71 offen sc1
    s_waitcnt vmcnt(0)
    v_xor_b32 v244, s92, v244
    v_xor_b32 v245, s93, v245
    v_xor_b32 v246, s94, v246
    v_xor_b32 v247, s95, v247
    v_or3_b32 v14, v244, v245, v246
    v_or_b32 v14, v14, v247
    v_and_b32 v14, 0xff, v14
    v_cmp_ne_u32 vcc, 0, v14
    s_cbranch_vccnz L_poll_7_r
L_poll_7_ok:
    v_mov_b32 v14, v244
    s_nop 1
    v_max_f32_dpp v14, v14, v14 quad_perm:[1,0,3,2] row_mask:0xf bank_mask:0xf
    s_nop 1
    v_max_f32_dpp v14, v14, v14 quad_perm:[2,3,0,1] row_mask:0xf bank_mask:0xf
    v_mov_b32 v15, v14
    s_nop 1
    v_permlane16_swap_b32 v15, v14
    v_max_f32 v14, v14, v15
    v_mov_b32 v15, v14
    s_nop 1
    v_permlane32_swap_b32 v15, v14
    v_max_f32 v14, v14, v15
    v_sub_f32 v244, v244, v14
    v_mul_f32 v244, 0x3fb8aa3b, v244
    v_exp_f32 v244, v244
    s_nop 0
    v_cndmask_b32 v244, 0, v244, s[76:77]
    v_mul_f32 v245, v244, v245
    s_nop 1
    v_add_f32_dpp v245, v245, v245 quad_perm:[1,0,3,2] row_mask:0xf bank_mask:0xf
    s_nop 1
    v_add_f32_dpp v245, v245, v245 quad_perm:[2,3,0,1] row_mask:0xf bank_mask:0xf
    v_mov_b32 v15, v245
    s_nop 1
    v_permlane16_swap_b32 v15, v245
    v_add_f32 v245, v245, v15
    v_mov_b32 v15, v245
    s_nop 1
    v_permlane32_swap_b32 v15, v245
    v_add_f32 v245, v245, v15
    v_rcp_f32 v245, v245
    s_nop 0
    v_mul_f32 v244, v244, v245
    s_nop 1
    v_mov_b32_dpp v245, v244 row_newbcast:0 row_mask:0xf bank_mask:0xf
    v_mov_b32_dpp v246, v244 row_newbcast:1 row_mask:0xf bank_mask:0xf
    v_mov_b32_dpp v247, v244 row_newbcast:2 row_mask:0xf bank_mask:0xf
    s_mov_b32 s68, 0
L_poll_8:
    buffer_load_dwordx4 v[220:223], v10, s[60:63], s70 offen sc1
    buffer_load_dwordx4 v[224:227], v10, s[60:63], s72 offen sc1
    buffer_load_dwordx4 v[228:231], v10, s[60:63], s73 offen sc1
    s_waitcnt vmcnt(2)
    v_xor_b32 v220, s92, v220
    v_xor_b32 v221, s93, v221
    v_xor_b32 v222, s94, v222
    v_xor_b32 v223, s95, v223
    v_or3_b32 v14, v220, v221, v222
    s_waitcnt vmcnt(1)
    v_xor_b32 v224, s92, v224
    v_xor_b32 v225, s93, v225
    v_xor_b32 v226, s94, v226
    v_xor_b32 v227, s95, v227
    v_or3_b32 v14, v14, v223, v224
    v_or3_b32 v14, v14, v225, v226
    s_waitcnt vmcnt(0)
    v_xor_b32 v228, s92, v228
    v_xor_b32 v229, s93, v229
    v_xor_b32 v230, s94, v230
    v_xor_b32 v231, s95, v231
    v_or3_b32 v14, v14, v227, v228
    v_or3_b32 v14, v14, v229, v230
    v_or_b32 v14, v14, v231
    v_and_b32 v14, 0xff, v14
    v_cmp_ne_u32 vcc, 0, v14
    s_cbranch_vccnz L_poll_8_r
L_poll_8_ok:
    v_mul_f32 v220, v245, v220
    v_mul_f32 v221, v245, v221
    v_mul_f32 v222, v245, v222
    v_mul_f32 v223, v245, v223
    v_fmac_f32 v220, v246, v224
    v_fmac_f32 v221, v246, v225
    v_fmac_f32 v222, v246, v226
    v_fmac_f32 v223, v246, v227
    v_fmac_f32 v220, v247, v228
    v_fmac_f32 v221, v247, v229
    v_fmac_f32 v222, v247, v230
    v_fmac_f32 v223, v247, v231
    s_nop 0
    v_permlane32_swap_b32 v220, v222
    v_permlane32_swap_b32 v221, v223
    v_add_f32 v220, v220, v222
    v_add_f32 v221, v221, v223
    s_nop 1
    v_permlane16_swap_b32 v220, v221
    v_add_f32 v220, v220, v221
    s_nop 1
    v_mov_b32_dpp v15, v220 row_ror:8 row_mask:0xf bank_mask:0xf
    v_cvt_pk_bf16_f32 v14, v220, v15
    s_nop 1
    v_mov_b32_dpp v16, v14 row_newbcast:0 row_mask:0xf bank_mask:0xf
    v_mov_b32_dpp v17, v14 row_newbcast:1 row_mask:0xf bank_mask:0xf
    v_perm_b32 v180, v16, v16, v192
    v_perm_b32 v181, v16, v16, v193
    v_perm_b32 v182, v16, v16, v194
    v_perm_b32 v183, v16, v16, v195
    v_perm_b32 v184, v17, v17, v192
    v_perm_b32 v185, v17, v17, v193
    v_perm_b32 v186, v17, v17, v194
    v_perm_b32 v187, v17, v17, v195
    v_mfma_f32_16x16x32_bf16 v[188:191], v[180:183], v[88:91], 0
    v_mov_b32_dpp v16, v14 row_newbcast:2 row_mask:0xf bank_mask:0xf
    v_perm_b32 v180, v16, v16, v192
    v_perm_b32 v181, v16, v16, v193
    v_perm_b32 v182, v16, v16, v194
    v_perm_b32 v183, v16, v16, v195
    v_mfma_f32_16x16x32_bf16 v[188:191], v[184:187], v[92:95], v[188:191]
    v_mov_b32_dpp v17, v14 row_newbcast:3 row_mask:0xf bank_mask:0xf
    v_perm_b32 v184, v17, v17, v192
    v_perm_b32 v185, v17, v17, v193
    v_perm_b32 v186, v17, v17, v194
    v_perm_b32 v187, v17, v17, v195
    v_mfma_f32_16x16x32_bf16 v[188:191], v[180:183], v[96:99], v[188:191]
    v_mov_b32_dpp v16, v14 row_newbcast:4 row_mask:0xf bank_mask:0xf
    v_perm_b32 v180, v16, v16, v192
    v_perm_b32 v181, v16, v16, v193
    v_perm_b32 v182, v16, v16, v194
    v_perm_b32 v183, v16, v16, v195
    v_mfma_f32_16x16x32_bf16 v[188:191], v[184:187], v[100:103], v[188:191]
    v_mov_b32_dpp v17, v14 row_newbcast:5 row_mask:0xf bank_mask:0xf
    v_perm_b32 v184, v17, v17, v192
    v_perm_b32 v185, v17, v17, v193
    v_perm_b32 v186, v17, v17, v194
    v_perm_b32 v187, v17, v17, v195
    v_mfma_f32_16x16x32_bf16 v[188:191], v[180:183], v[104:107], v[188:191]
    v_mov_b32_dpp v16, v14 row_newbcast:6 row_mask:0xf bank_mask:0xf
    v_perm_b32 v180, v16, v16, v192
    v_perm_b32 v181, v16, v16, v193
    v_perm_b32 v182, v16, v16, v194
    v_perm_b32 v183, v16, v16, v195
    v_mfma_f32_16x16x32_bf16 v[188:191], v[184:187], v[108:111], v[188:191]
    v_mov_b32_dpp v17, v14 row_newbcast:7 row_mask:0xf bank_mask:0xf
    v_perm_b32 v184, v17, v17, v192
    v_perm_b32 v185, v17, v17, v193
    v_perm_b32 v186, v17, v17, v194
    v_perm_b32 v187, v17, v17, v195
    v_mfma_f32_16x16x32_bf16 v[188:191], v[180:183], v[112:115], v[188:191]
    s_nop 0
    v_mfma_f32_16x16x32_bf16 v[188:191], v[184:187], v[116:119], v[188:191]
    s_mov_b64 exec, s[78:79]
    s_nop 6
    ds_write_b128 v249, v[188:191]
    s_mov_b64 exec, -1
    s_waitcnt lgkmcnt(0)
    s_barrier
    ds_read_b128 v[16:19], v250 offset:0
    ds_read_b128 v[20:23], v250 offset:1024
    ds_read_b128 v[24:27], v250 offset:2048
    ds_read_b128 v[28:31], v250 offset:3072
    s_waitcnt lgkmcnt(2)
    v_pk_add_f32 v[16:17], v[16:17], v[20:21]
    v_pk_add_f32 v[18:19], v[18:19], v[22:23]
    s_waitcnt lgkmcnt(0)
    v_pk_add_f32 v[24:25], v[24:25], v[28:29]
    v_pk_add_f32 v[26:27], v[26:27], v[30:31]
    v_pk_add_f32 v[16:17], v[16:17], v[24:25]
    v_pk_add_f32 v[18:19], v[18:19], v[26:27]
    s_nop 1
    v_permlane32_swap_b32 v16, v18
    v_permlane32_swap_b32 v17, v19
    v_add_f32 v16, v16, v18
    v_add_f32 v17, v17, v19
    s_nop 1
    v_permlane16_swap_b32 v16, v17
    v_add_f32 v16, v16, v17
    v_and_or_b32 v16, v16, s74, v197
    buffer_store_dword v16, v251, s[60:63], s69 offen sc1
L_w_fin:
    s_mul_i32 s70, s41, 9
    s_add_u32 s70, s70, s42
    s_and_b32 s38, s70, 3
    s_cmp_eq_u32 s38, 0
    s_cbranch_scc0 L_w_exit
    s_cmp_ge_u32 s40, 6
    s_cbranch_scc1 L_w_exit
    s_lshl_b32 s70, s70, 5
    s_lshr_b32 s71, s70, 1
    v_and_b32 v10, 7, v0
    v_lshlrev_b32 v10, 4, v10
    v_lshrrev_b32 v11, 3, v0
    v_mul_u32_u24 v11, 2304, v11
    v_add_u32 v11, v11, v10
    v_lshl_add_u32 v15, v2, 2, v10
    v_lshrrev_b32 v12, 1, v15
    s_mov_b32 s56, s32
    s_mov_b32 s57, s33
    s_mov_b32 s58, 1152
    s_mov_b32 s59, 0x20000
    s_mov_b32 s76, 0x00ff00ff
    s_mov_b32 s77, 0x00ff00ff
    s_cmp_eq_u32 s40, 0
    s_cbranch_scc0 L_w_fin3
    s_mov_b32 s48, s8
    s_mov_b32 s49, s9
    s_mov_b32 s50, 1152
    s_mov_b32 s51, 0x20000
    s_mov_b32 s52, s26
    s_mov_b32 s53, s27
    s_mov_b32 s54, 1152
    s_mov_b32 s55, 0x20000
    buffer_load_ushort v20, v12, s[48:51], s71 offen
    buffer_load_ushort v21, v12, s[52:55], s71 offen
    buffer_load_ushort v25, v12, s[56:59], s71 offen
    v_bfe_u32 v26, v0, 3, 2
    v_mul_u32_u24 v26, 13824, v26
    v_lshrrev_b32 v27, 5, v0
    v_mul_u32_u24 v27, 6912, v27
    v_add3_u32 v26, v26, v27, v10
    s_add_u32 s72, s70, 8704
    s_mul_i32 s74, s41, 18432
    s_add_u32 s74, s74, s70
    s_add_u32 s74, s74, 2097152
    s_mov_b32 s68, 0
L_poll_9:
    buffer_load_dwordx4 v[28:31], v26, s[60:63], s72 offen sc1
    buffer_load_dwordx4 v[32:35], v11, s[60:63], s74 offen sc1
    s_waitcnt vmcnt(1)
    v_xor_b32 v28, s92, v28
    v_xor_b32 v29, s93, v29
    v_xor_b32 v30, s94, v30
    v_xor_b32 v31, s95, v31
    v_or3_b32 v27, v28, v29, v30
    s_waitcnt vmcnt(0)
    v_xor_b32 v32, s92, v32
    v_xor_b32 v33, s93, v33
    v_xor_b32 v34, s94, v34
    v_xor_b32 v35, s95, v35
    v_or3_b32 v27, v27, v31, v32
    v_or3_b32 v27, v27, v33, v34
    v_or_b32 v27, v27, v35
    v_and_b32 v27, 0xff, v27
    v_cmp_ne_u32 vcc, 0, v27
    s_cbranch_vccnz L_poll_9_r
L_poll_9_ok:
    v_permlane16_swap_b32 v28, v29
    v_permlane16_swap_b32 v30, v31
    v_add_f32 v22, v28, v29
    v_add_f32 v23, v30, v31
    v_permlane32_swap_b32 v32, v34
    v_permlane32_swap_b32 v33, v35
    v_add_f32 v32, v32, v34
    v_add_f32 v33, v33, v35
    s_nop 1
    v_permlane16_swap_b32 v32, v33
    v_add_f32 v32, v32, v33
    v_permlane32_swap_b32 v22, v23
    s_nop 0
    v_add_f32_dpp v24, v32, v32 row_ror:8 row_mask:0xf bank_mask:0xf
    v_add_f32_dpp v22, v22, v22 row_ror:8 row_mask:0xf bank_mask:0xf
    v_add_f32_dpp v23, v23, v23 row_ror:8 row_mask:0xf bank_mask:0xf
    v_lshlrev_b32 v20, 16, v20
    v_lshlrev_b32 v21, 16, v21
    v_cvt_pk_bf16_f32 v26, v22, v23
    v_lshlrev_b32 v22, 16, v26
    v_and_b32 v23, 0xffff0000, v26
    v_cvt_pk_bf16_f32 v24, v24, v24
    v_and_b32 v24, 0xffff0000, v24
    v_mul_f32 v24, v24, v22
    v_cvt_pk_bf16_f32 v24, v24, v24
    v_and_b32 v24, 0xffff0000, v24
    v_add_f32 v24, v24, v20
    v_cvt_pk_bf16_f32 v24, v24, v24
    v_and_b32 v24, 0xffff0000, v24
L_w_fin3:
    s_mul_i32 s72, s40, 55296
    s_add_u32 s72, s72, s70
    s_add_u32 s72, s72, 333824
    s_add_u32 s73, s72, 18432
    s_add_u32 s74, s72, 36864
    s_lshl_b32 s38, s40, 7
    s_add_u32 s38, s38, 3584
    v_add_u32 v14, s38, v15
    v_add_u32 v15, 3584, v15
    s_mov_b32 s68, 0
L_poll_10:
    buffer_load_dwordx4 v[36:39], v11, s[60:63], s72 offen sc1
    buffer_load_dwordx4 v[40:43], v11, s[60:63], s73 offen sc1
    buffer_load_dwordx4 v[44:47], v11, s[60:63], s74 offen sc1
    s_waitcnt vmcnt(2)
    v_xor_b32 v36, s92, v36
    v_xor_b32 v37, s93, v37
    v_xor_b32 v38, s94, v38
    v_xor_b32 v39, s95, v39
    v_or3_b32 v19, v36, v37, v38
    s_waitcnt vmcnt(1)
    v_xor_b32 v40, s92, v40
    v_xor_b32 v41, s93, v41
    v_xor_b32 v42, s94, v42
    v_xor_b32 v43, s95, v43
    v_or3_b32 v19, v19, v39, v40
    v_or3_b32 v19, v19, v41, v42
    s_waitcnt vmcnt(0)
    v_xor_b32 v44, s92, v44
    v_xor_b32 v45, s93, v45
    v_xor_b32 v46, s94, v46
    v_xor_b32 v47, s95, v47
    v_or3_b32 v19, v19, v43, v44
    v_or3_b32 v19, v19, v45, v46
    v_or_b32 v19, v19, v47
    v_and_b32 v19, 0xff, v19
    v_cmp_ne_u32 vcc, 0, v19
    s_cbranch_vccnz L_poll_10_r
L_poll_10_ok:
    v_pk_add_f32 v[36:37], v[36:37], v[40:41]
    v_pk_add_f32 v[38:39], v[38:39], v[42:43]
    v_pk_add_f32 v[36:37], v[36:37], v[44:45]
    v_pk_add_f32 v[38:39], v[38:39], v[46:47]
    s_nop 1
    v_permlane32_swap_b32 v36, v38
    v_permlane32_swap_b32 v37, v39
    v_add_f32 v36, v36, v38
    v_add_f32 v37, v37, v39
    s_nop 1
    v_permlane16_swap_b32 v36, v37
    v_add_f32 v36, v36, v37
    s_nop 1
    v_add_f32_dpp v36, v36, v36 row_ror:8 row_mask:0xf bank_mask:0xf
    s_mov_b64 exec, s[76:77]
    ds_write_b32 v14, v36
    s_waitcnt lgkmcnt(0)
    s_barrier
    s_cmp_eq_u32 s40, 0
    s_cbranch_scc0 L_w_exit
    ds_read2_b32 v[26:27], v15 offset0:0 offset1:32
    ds_read2_b32 v[28:29], v15 offset0:64 offset1:96
    ds_read2_b32 v[30:31], v15 offset0:128 offset1:160
    s_waitcnt lgkmcnt(0)
    v_pk_add_f32 v[26:27], v[26:27], v[28:29]
    v_pk_add_f32 v[26:27], v[26:27], v[30:31]
    v_add_f32 v26, v26, v27
    v_cvt_pk_bf16_f32 v26, v26, v26
    v_and_b32 v26, 0xffff0000, v26
    v_add_f32 v26, v26, v21
    v_cvt_pk_bf16_f32 v26, v26, v26
    v_and_b32 v26, 0xffff0000, v26
    v_mul_f32 v26, v26, v23
    v_cvt_pk_bf16_f32 v26, v26, v26
    v_and_b32 v26, 0xffff0000, v26
    v_add_f32 v26, v26, v24
    v_cvt_pk_bf16_f32 v26, v26, v26
    buffer_store_short v26, v12, s[56:59], s71 offen
    s_cmp_eq_u32 s2, 0
    s_cbranch_scc0 L_w_exit
    s_mov_b64 exec, 1
    v_mov_b32 v27, 0
    buffer_store_dword v196, v27, s[60:63], 0 offen offset:0
L_w_exit:
    s_mov_b64 exec, -1
    s_endpgm
L_s4_one:
    s_mov_b32 s68, 0
L_cst_11:
    v_xor_b32 v40, s92, v40
    v_xor_b32 v41, s93, v41
    v_xor_b32 v42, s94, v42
    v_xor_b32 v43, s95, v43
    v_or3_b32 v4, v40, v41, v42
    v_xor_b32 v44, s92, v44
    v_xor_b32 v45, s93, v45
    v_xor_b32 v46, s94, v46
    v_xor_b32 v47, s95, v47
    v_or3_b32 v4, v4, v43, v44
    v_or3_b32 v4, v4, v45, v46
    v_xor_b32 v48, s92, v48
    v_xor_b32 v49, s93, v49
    v_xor_b32 v50, s94, v50
    v_xor_b32 v51, s95, v51
    v_or3_b32 v4, v4, v47, v48
    v_or3_b32 v4, v4, v49, v50
    v_or_b32 v4, v4, v51
    v_and_b32 v4, 0xff, v4
    v_cmp_ne_u32 vcc, 0, v4
    s_cbranch_vccnz L_cstr_12
L_cst_11_ok:
    v_permlane32_swap_b32 v40, v42
    v_permlane32_swap_b32 v41, v43
    v_add_f32 v40, v40, v42
    v_add_f32 v41, v41, v43
    s_nop 1
    v_permlane16_swap_b32 v40, v41
    v_add_f32 v40, v40, v41
    v_permlane32_swap_b32 v44, v46
    v_permlane32_swap_b32 v45, v47
    v_add_f32 v44, v44, v46
    v_add_f32 v45, v45, v47
    s_nop 1
    v_permlane16_swap_b32 v44, v45
    v_add_f32 v44, v44, v45
    v_permlane32_swap_b32 v48, v50
    v_permlane32_swap_b32 v49, v51
    v_add_f32 v48, v48, v50
    v_add_f32 v49, v49, v51
    s_nop 1
    v_permlane16_swap_b32 v48, v49
    v_add_f32 v48, v48, v49
    v_cvt_pk_bf16_f32 v4, v40, v44
    v_lshlrev_b32 v40, 16, v4
    v_and_b32 v44, 0xffff0000, v4
    v_cvt_pk_bf16_f32 v48, v48, v48
    v_and_b32 v48, 0xffff0000, v48
    v_lshlrev_b32 v8, 16, v52
    v_mov_b32 v9, v40
    v_mov_b32 v11, v44
    v_add_f32 v10, 1.0, v48
    v_cvt_pk_bf16_f32 v10, v10, v10
    v_and_b32 v10, 0xffff0000, v10
    v_lshlrev_b32 v12, 4, v1
    v_lshl_add_u32 v12, v2, 2, v12
    v_add_u32 v12, s77, v12
    ds_write_b32 v12, v10 offset:14208
    ds_write_b32 v12, v11 offset:16512
    s_lshr_b32 s38, s77, 2
    s_add_u32 s38, s38, 18816
    v_and_b32 v14, 1, v2
    v_lshlrev_b32 v14, 3, v14
    v_lshrrev_b32 v15, 1, v2
    v_lshlrev_b32 v15, 2, v15
    v_add3_u32 v14, v14, v15, s38
    v_add3_u32 v15, v15, 16, s38
    v_add_u32 v16, 32, v14
    v_add_u32 v17, 32, v15
    v_add_f32 v11, v11, v11
    v_mov_b32 v18, v10
    v_mul_f32 v19, v10, v10
    v_mul_f32 v20, v10, v11
    v_mul_f32 v21, 0.5, v11
    v_mul_f32 v22, v21, v21
    v_mov_b32 v23, 0
    v_permlane32_swap_b32 v18, v19
    v_permlane32_swap_b32 v20, v21
    v_permlane32_swap_b32 v22, v23
    v_add_f32 v18, v18, v19
    v_add_f32 v20, v20, v21
    v_add_f32 v22, v22, v23
    v_mov_b32 v24, v22
    v_permlane16_swap_b32 v18, v20
    s_nop 0
    v_permlane16_swap_b32 v24, v22
    v_add_f32 v18, v18, v20
    v_add_f32 v22, v22, v24
    s_nop 0
    v_add_f32_dpp v18, v18, v18 quad_perm:[1,0,3,2] row_mask:0xf bank_mask:0xf
    v_add_f32_dpp v22, v22, v22 quad_perm:[1,0,3,2] row_mask:0xf bank_mask:0xf
    s_nop 0
    v_add_f32_dpp v18, v18, v18 quad_perm:[2,3,0,1] row_mask:0xf bank_mask:0xf
    v_add_f32_dpp v22, v22, v22 quad_perm:[2,3,0,1] row_mask:0xf bank_mask:0xf
    s_nop 0
    v_add_f32_dpp v18, v18, v18 row_half_mirror row_mask:0xf bank_mask:0xf
    v_add_f32_dpp v22, v22, v22 row_half_mirror row_mask:0xf bank_mask:0xf
    s_nop 0
    v_add_f32_dpp v18, v18, v18 row_mirror row_mask:0xf bank_mask:0xf
    v_add_f32_dpp v22, v22, v22 row_mirror row_mask:0xf bank_mask:0xf
    s_mov_b64 exec, s[78:79]
    ds_write_b32 v16, v18
    ds_write_b32 v17, v22
    s_mov_b64 exec, -1
    v_add_f32 v25, v10, v10
    v_mul_u32_u24 v13, 2304, v2
    v_lshl_add_u32 v13, v1, 4, v13
    v_add_u32 v13, s77, v13
    s_cmp_ge_u32 s40, 4
    s_cbranch_scc0 L_wda0
    s_waitcnt vmcnt(30)
    v_mov_b32 v4, 116
    v_mov_b32 v5, 1
    s_mov_b64 exec, 1
    ds_add_u32 v4, v5
    s_mov_b64 exec, -1
L_wda0:
    v_mov_b32 v4, 116
    s_mov_b32 s68, 0
L_wda:
    ds_read_b32 v5, v4
    s_waitcnt lgkmcnt(0)
    v_cmp_le_u32 vcc, 4, v5
    s_cbranch_vccnz L_wda_ok
    s_sleep 1
    s_add_u32 s68, s68, 1
    s_cmp_lt_u32 s68, 320000
    s_cbranch_scc1 L_wda
L_wda_ok:
    s_mov_b32 s68, 0
L_poll_13:
    buffer_load_dwordx4 v[56:59], v13, s[60:63], s74 offen sc1
    buffer_load_dwordx4 v[60:63], v13, s[60:63], s75 offen sc1
    s_waitcnt vmcnt(1)
    v_xor_b32 v56, s92, v56
    v_xor_b32 v57, s93, v57
    v_xor_b32 v58, s94, v58
    v_xor_b32 v59, s95, v59
    v_or3_b32 v4, v56, v57, v58
    s_waitcnt vmcnt(0)
    v_xor_b32 v60, s92, v60
    v_xor_b32 v61, s93, v61
    v_xor_b32 v62, s94, v62
    v_xor_b32 v63, s95, v63
    v_or3_b32 v4, v4, v59, v60
    v_or3_b32 v4, v4, v61, v62
    v_or_b32 v4, v4, v63
    v_and_b32 v4, 0xff, v4
    v_cmp_ne_u32 vcc, 0, v4
    s_cbranch_vccnz L_poll_13_r
L_poll_13_ok:
    v_pk_add_f32 v[56:57], v[56:57], v[60:61]
    v_pk_add_f32 v[58:59], v[58:59], v[62:63]
    s_nop 1
    v_permlane32_swap_b32 v56, v58
    v_permlane32_swap_b32 v57, v59
    v_add_f32 v56, v56, v58
    v_add_f32 v57, v57, v59
    s_nop 1
    v_permlane16_swap_b32 v56, v57
    v_add_f32 v56, v56, v57
    v_fma_f32 v18, v9, v56, v8
    v_mul_f32 v20, v10, v18
    v_mul_f32 v19, v18, v18
    ds_write_b32 v12, v20 offset:11904
    v_mul_f32 v21, v25, v20
    v_mul_f32 v22, v20, v20
    v_mul_f32 v23, v11, v20
    v_permlane32_swap_b32 v18, v19
    v_permlane32_swap_b32 v20, v21
    v_permlane32_swap_b32 v22, v23
    v_add_f32 v18, v18, v19
    v_add_f32 v20, v20, v21
    v_add_f32 v22, v22, v23
    v_mov_b32 v24, v22
    v_permlane16_swap_b32 v18, v20
    s_nop 0
    v_permlane16_swap_b32 v24, v22
    v_add_f32 v18, v18, v20
    v_add_f32 v22, v22, v24
    s_nop 0
    v_add_f32_dpp v18, v18, v18 quad_perm:[1,0,3,2] row_mask:0xf bank_mask:0xf
    v_add_f32_dpp v22, v22, v22 quad_perm:[1,0,3,2] row_mask:0xf bank_mask:0xf
    s_nop 0
    v_add_f32_dpp v18, v18, v18 quad_perm:[2,3,0,1] row_mask:0xf bank_mask:0xf
    v_add_f32_dpp v22, v22, v22 quad_perm:[2,3,0,1] row_mask:0xf bank_mask:0xf
    s_nop 0
    v_add_f32_dpp v18, v18, v18 row_half_mirror row_mask:0xf bank_mask:0xf
    v_add_f32_dpp v22, v22, v22 row_half_mirror row_mask:0xf bank_mask:0xf
    s_nop 0
    v_add_f32_dpp v18, v18, v18 row_mirror row_mask:0xf bank_mask:0xf
    v_add_f32_dpp v22, v22, v22 row_mirror row_mask:0xf bank_mask:0xf
    s_mov_b64 exec, s[78:79]
    ds_write_b32 v14, v18
    ds_write_b32 v15, v22
    s_mov_b64 exec, -1
    s_branch L_s4_bar
L_st_retry:
    s_add_u32 s68, s68, 1
    s_cmp_lt_u32 s68, 320000
    s_cbranch_scc1 L_st_loop
    s_branch L_st_ok
L_st_slow:
    buffer_store_dwordx4 v[84:87], v33, s[60:63], s74 offen offset:1024 sc1
    s_branch L_st_done
L_att_slow:
    buffer_store_dwordx4 v[72:75], v32, s[60:63], s74 offen sc1
    s_branch L_att_pub
L_mh_1:
    s_mov_b32 s68, 0
L_mh_1_l:
    v_cmp_lt_u32 vcc, 1, v14
    s_cbranch_vccnz L_mb_1
    ds_read_b32 v14, v11
    s_add_u32 s68, s68, 1
    s_cmp_lt_u32 s68, 320000
    s_waitcnt lgkmcnt(0)
    s_cbranch_scc1 L_mh_1_l
    s_branch L_mb_1
L_mh_2:
    s_mov_b32 s68, 0
L_mh_2_l:
    v_cmp_lt_u32 vcc, 1, v14
    s_cbranch_vccnz L_mb_2
    ds_read_b32 v14, v11
    s_add_u32 s68, s68, 1
    s_cmp_lt_u32 s68, 320000
    s_waitcnt lgkmcnt(0)
    s_cbranch_scc1 L_mh_2_l
    s_branch L_mb_2
L_mh_3:
    s_mov_b32 s68, 0
L_mh_3_l:
    v_cmp_lt_u32 vcc, 1, v14
    s_cbranch_vccnz L_mb_3
    ds_read_b32 v14, v11
    s_add_u32 s68, s68, 1
    s_cmp_lt_u32 s68, 320000
    s_waitcnt lgkmcnt(0)
    s_cbranch_scc1 L_mh_3_l
    s_branch L_mb_3
L_mh_4:
    s_mov_b32 s68, 0
L_mh_4_l:
    v_cmp_lt_u32 vcc, 1, v14
    s_cbranch_vccnz L_mb_4
    ds_read_b32 v14, v11
    s_add_u32 s68, s68, 1
    s_cmp_lt_u32 s68, 320000
    s_waitcnt lgkmcnt(0)
    s_cbranch_scc1 L_mh_4_l
    s_branch L_mb_4
L_mh_5:
    s_mov_b32 s68, 0
L_mh_5_l:
    v_cmp_lt_u32 vcc, 1, v14
    s_cbranch_vccnz L_mb_5
    ds_read_b32 v14, v11
    s_add_u32 s68, s68, 1
    s_cmp_lt_u32 s68, 320000
    s_waitcnt lgkmcnt(0)
    s_cbranch_scc1 L_mh_5_l
    s_branch L_mb_5
L_mh_6:
    s_mov_b32 s68, 0
L_mh_6_l:
    v_cmp_lt_u32 vcc, 1, v14
    s_cbranch_vccnz L_mb_6
    ds_read_b32 v14, v11
    s_add_u32 s68, s68, 1
    s_cmp_lt_u32 s68, 320000
    s_waitcnt lgkmcnt(0)
    s_cbranch_scc1 L_mh_6_l
    s_branch L_mb_6
L_mh_7:
    s_mov_b32 s68, 0
L_mh_7_l:
    v_cmp_lt_u32 vcc, 1, v14
    s_cbranch_vccnz L_mb_7
    ds_read_b32 v14, v11
    s_add_u32 s68, s68, 1
    s_cmp_lt_u32 s68, 320000
    s_waitcnt lgkmcnt(0)
    s_cbranch_scc1 L_mh_7_l
    s_branch L_mb_7
L_mh_8:
    s_mov_b32 s68, 0
L_mh_8_l:
    v_cmp_lt_u32 vcc, 1, v14
    s_cbranch_vccnz L_mb_8
    ds_read_b32 v14, v11
    s_add_u32 s68, s68, 1
    s_cmp_lt_u32 s68, 320000
    s_waitcnt lgkmcnt(0)
    s_cbranch_scc1 L_mh_8_l
    s_branch L_mb_8
L_mh_9:
    s_mov_b32 s68, 0
L_mh_9_l:
    v_cmp_lt_u32 vcc, 1, v14
    s_cbranch_vccnz L_mb_9
    ds_read_b32 v14, v11
    s_add_u32 s68, s68, 1
    s_cmp_lt_u32 s68, 320000
    s_waitcnt lgkmcnt(0)
    s_cbranch_scc1 L_mh_9_l
    s_branch L_mb_9
L_mh_10:
    s_mov_b32 s68, 0
L_mh_10_l:
    v_cmp_lt_u32 vcc, 1, v14
    s_cbranch_vccnz L_mb_10
    ds_read_b32 v14, v11
    s_add_u32 s68, s68, 1
    s_cmp_lt_u32 s68, 320000
    s_waitcnt lgkmcnt(0)
    s_cbranch_scc1 L_mh_10_l
    s_branch L_mb_10
L_mh_11:
    s_mov_b32 s68, 0
L_mh_11_l:
    v_cmp_lt_u32 vcc, 1, v14
    s_cbranch_vccnz L_mb_11
    ds_read_b32 v14, v11
    s_add_u32 s68, s68, 1
    s_cmp_lt_u32 s68, 320000
    s_waitcnt lgkmcnt(0)
    s_cbranch_scc1 L_mh_11_l
    s_branch L_mb_11
L_mh_12:
    s_mov_b32 s68, 0
L_mh_12_l:
    v_cmp_lt_u32 vcc, 1, v14
    s_cbranch_vccnz L_mb_12
    ds_read_b32 v14, v11
    s_add_u32 s68, s68, 1
    s_cmp_lt_u32 s68, 320000
    s_waitcnt lgkmcnt(0)
    s_cbranch_scc1 L_mh_12_l
    s_branch L_mb_12
L_mh_13:
    s_mov_b32 s68, 0
L_mh_13_l:
    v_cmp_lt_u32 vcc, 1, v14
    s_cbranch_vccnz L_mb_13
    ds_read_b32 v14, v11
    s_add_u32 s68, s68, 1
    s_cmp_lt_u32 s68, 320000
    s_waitcnt lgkmcnt(0)
    s_cbranch_scc1 L_mh_13_l
    s_branch L_mb_13
L_mh_14:
    s_mov_b32 s68, 0
L_mh_14_l:
    v_cmp_lt_u32 vcc, 1, v14
    s_cbranch_vccnz L_mb_14
    ds_read_b32 v14, v11
    s_add_u32 s68, s68, 1
    s_cmp_lt_u32 s68, 320000
    s_waitcnt lgkmcnt(0)
    s_cbranch_scc1 L_mh_14_l
    s_branch L_mb_14
L_mh_15:
    s_mov_b32 s68, 0
L_mh_15_l:
    v_cmp_lt_u32 vcc, 1, v14
    s_cbranch_vccnz L_mb_15
    ds_read_b32 v14, v11
    s_add_u32 s68, s68, 1
    s_cmp_lt_u32 s68, 320000
    s_waitcnt lgkmcnt(0)
    s_cbranch_scc1 L_mh_15_l
    s_branch L_mb_15
L_mh_16:
    s_mov_b32 s68, 0
L_mh_16_l:
    v_cmp_lt_u32 vcc, 1, v14
    s_cbranch_vccnz L_mb_16
    ds_read_b32 v14, v11
    s_add_u32 s68, s68, 1
    s_cmp_lt_u32 s68, 320000
    s_waitcnt lgkmcnt(0)
    s_cbranch_scc1 L_mh_16_l
    s_branch L_mb_16
L_cstr_2:
    s_mov_b32 s38, 8704
    s_mov_b32 s39, 13312
    buffer_load_dwordx4 v[40:43], v54, s[60:63], s38 offen sc1
    buffer_load_dwordx4 v[44:47], v54, s[60:63], s38 offen offset:2304 sc1
    buffer_load_dwordx4 v[48:51], v54, s[60:63], s39 offen sc1
    s_add_u32 s68, s68, 1
    s_cmp_lt_u32 s68, 40000
    s_waitcnt vmcnt(0)
    s_cbranch_scc1 L_cst_1
    s_branch L_cst_1_ok
L_cstr_4:
    s_mov_b32 s38, 8704
    s_mov_b32 s39, 13312
    buffer_load_dwordx4 v[56:59], v70, s[60:63], s38 offen sc1
    buffer_load_dwordx4 v[60:63], v70, s[60:63], s38 offen offset:2304 sc1
    buffer_load_dwordx4 v[64:67], v70, s[60:63], s39 offen sc1
    s_add_u32 s68, s68, 1
    s_cmp_lt_u32 s68, 40000
    s_waitcnt vmcnt(0)
    s_cbranch_scc1 L_cst_3
    s_branch L_cst_3_ok
L_poll_5_r:
    s_add_u32 s68, s68, 1
    s_cmp_lt_u32 s68, 40000
    s_cbranch_scc1 L_poll_5
    s_branch L_poll_5_ok
L_ex_r:
    s_cmp_eq_u32 s68, 6
    s_cbranch_scc0 L_ex_r2
    s_mov_b32 exec_hi, 0
    s_mov_b32 exec_lo, s21
    buffer_store_dwordx4 v[40:43], v226, s[60:63], s19 offen sc1
    s_mov_b64 exec, -1
L_ex_r2:
    buffer_load_dword v18, v227, s[60:63], s16 offen sc1
    buffer_load_dword v19, v227, s[60:63], s16 offen offset:128 sc1
    s_add_u32 s68, s68, 1
    s_cmp_lt_u32 s68, 40000
    s_cbranch_scc1 L_ex
    s_branch L_ex_ok
L_tile_a:
    s_mov_b32 s78, 0x00ff00ff
    s_mov_b32 s79, 0
    s_mul_i32 s71, s46, 384
    s_add_u32 s71, s71, 6272
    s_mul_i32 s38, s41, 18
    s_add_u32 s45, s45, s38
    s_sub_u32 s45, s45, 2
    s_waitcnt lgkmcnt(0)
    s_barrier
    s_load_dword s43, s[36:37], 0
    s_mov_b32 s60, s36
    s_mov_b32 s61, s37
    s_mov_b32 s62, 3145728
    s_mov_b32 s63, 0x20000
    s_waitcnt lgkmcnt(0)
    s_add_u32 s43, s43, 0x01010101
    s_mov_b32 s4, 0x07060500
    s_bfe_u32 s92, s43, 0x80000
    s_mov_b32 s5, 0x07060501
    s_bfe_u32 s93, s43, 0x80008
    s_mov_b32 s6, 0x07060502
    s_bfe_u32 s94, s43, 0x80010
    s_mov_b32 s7, 0x07060503
    s_bfe_u32 s95, s43, 0x80018
    v_mov_b32 v196, s43
    v_bfe_u32 v13, v0, 3, 1
    v_mul_u32_u24 v13, 0x202, v13
    v_add_u32 v13, 0x100, v13
    v_and_b32 v14, 1, v0
    v_lshlrev_b32 v14, 4, v14
    v_lshlrev_b32 v13, v14, v13
    v_mov_b32 v15, 0x0c0c0000
    v_lshrrev_b32 v14, v14, v15
    v_or_b32 v13, v13, v14
    v_bfe_u32 v14, v0, 1, 2
    v_mov_b32 v15, 0x0c0c0c0c
    v_cmp_eq_u32 vcc, 0, v14
    s_nop 1
    v_cndmask_b32 v192, v15, v13, vcc
    v_cmp_eq_u32 vcc, 1, v14
    s_nop 1
    v_cndmask_b32 v193, v15, v13, vcc
    v_cmp_eq_u32 vcc, 2, v14
    s_nop 1
    v_cndmask_b32 v194, v15, v13, vcc
    v_cmp_eq_u32 vcc, 3, v14
    s_nop 1
    v_cndmask_b32 v195, v15, v13, vcc
    v_mov_b32 v11, 104
    s_mov_b32 s68, 0
L_go1:
    ds_read_b32 v14, v11
    s_waitcnt lgkmcnt(0)
    v_cmp_le_u32 vcc, 1, v14
    s_cbranch_vccnz L_go1_ok
    s_sleep 4
    s_add_u32 s68, s68, 1
    s_cmp_lt_u32 s68, 320000
    s_cbranch_scc1 L_go1
L_go1_ok:
    s_mov_b32 s44, 1
L_tile:
    v_lshrrev_b32 v3, 3, v1
    v_lshl_add_u32 v3, v2, 1, v3
    v_and_b32 v4, 7, v1
    v_lshlrev_b32 v4, 4, v4
    s_mov_b32 s48, s30
    s_mov_b32 s49, s31
    s_mov_b32 s50, 3981312
    s_mov_b32 s51, 0x20000
    s_and_b32 s46, s45, 3
    s_lshr_b32 s45, s45, 2
    s_add_u32 s45, s45, 18
    s_mov_b32 s56, s28
    s_mov_b32 s57, s29
    s_mov_b32 s58, 1152
    s_mov_b32 s59, 0x20000
    s_mul_i32 s38, s46, 288
    v_lshl_add_u32 v6, v0, 1, s38
    buffer_load_ushort v10, v6, s[56:59], 0 offen offset:0
    buffer_load_ushort v11, v6, s[56:59], 0 offen offset:128
    buffer_load_ushort v12, v6, s[56:59], 0 offen offset:256
    v_mul_u32_u24 v6, 6912, v3
    v_add_u32 v6, v6, v4
    s_mul_i32 s38, s46, 995328
    s_lshl_b32 s39, s45, 7
    s_add_u32 s38, s38, s39
    buffer_load_dwordx4 v[16:19], v6, s[48:51], s38 offen nt
    s_add_u32 s38, s38, 55296
    buffer_load_dwordx4 v[20:23], v6, s[48:51], s38 offen nt
    s_add_u32 s38, s38, 55296
    buffer_load_dwordx4 v[24:27], v6, s[48:51], s38 offen nt
    s_add_u32 s38, s38, 55296
    buffer_load_dwordx4 v[28:31], v6, s[48:51], s38 offen nt
    s_add_u32 s38, s38, 55296
    buffer_load_dwordx4 v[32:35], v6, s[48:51], s38 offen nt
    s_add_u32 s38, s38, 55296
    buffer_load_dwordx4 v[36:39], v6, s[48:51], s38 offen nt
    s_add_u32 s38, s38, 55296
    buffer_load_dwordx4 v[40:43], v6, s[48:51], s38 offen nt
    s_add_u32 s38, s38, 55296
    buffer_load_dwordx4 v[44:47], v6, s[48:51], s38 offen nt
    s_add_u32 s38, s38, 55296
    buffer_load_dwordx4 v[48:51], v6, s[48:51], s38 offen nt
    s_add_u32 s38, s38, 55296
    buffer_load_dwordx4 v[52:55], v6, s[48:51], s38 offen nt
    s_add_u32 s38, s38, 55296
    buffer_load_dwordx4 v[56:59], v6, s[48:51], s38 offen nt
    s_add_u32 s38, s38, 55296
    buffer_load_dwordx4 v[60:63], v6, s[48:51], s38 offen nt
    s_add_u32 s38, s38, 55296
    buffer_load_dwordx4 v[64:67], v6, s[48:51], s38 offen nt
    s_add_u32 s38, s38, 55296
    buffer_load_dwordx4 v[68:71], v6, s[48:51], s38 offen nt
    s_add_u32 s38, s38, 55296
    buffer_load_dwordx4 v[72:75], v6, s[48:51], s38 offen nt
    s_add_u32 s38, s38, 55296
    buffer_load_dwordx4 v[76:79], v6, s[48:51], s38 offen nt
    s_add_u32 s38, s38, 55296
    buffer_load_dwordx4 v[80:83], v6, s[48:51], s38 offen nt
    s_add_u32 s38, s38, 55296
    buffer_load_dwordx4 v[84:87], v6, s[48:51], s38 offen nt
    v_lshl_add_u32 v13, v0, 1, s71
    v_lshl_add_u32 v14, v2, 2, s71
    s_mul_i32 s70, s46, 13824
    s_lshl_b32 s39, s45, 8
    s_add_u32 s70, s70, s39
    s_add_u32 s70, s70, 4096
    s_waitcnt vmcnt(18)
    v_lshlrev_b32 v10, 16, v10
    v_lshlrev_b32 v11, 16, v11
    v_lshlrev_b32 v12, 16, v12
    s_mov_b32 s38, 0xbfb8aa3b
    v_mul_f32 v160, s38, v10
    v_mul_f32 v161, s38, v11
    v_mul_f32 v162, s38, v12
    v_fma_f32 v163, v10, s38, -v160
    v_fma_f32 v164, v11, s38, -v161
    v_fma_f32 v165, v12, s38, -v162
    v_exp_f32 v160, v160
    v_exp_f32 v161, v161
    v_exp_f32 v162, v162
    v_fmac_f32 v163, 0xb2a57060, v10
    v_fmac_f32 v164, 0xb2a57060, v11
    v_fmac_f32 v165, 0xb2a57060, v12
    v_mul_f32 v163, 0x3f317218, v163
    v_mul_f32 v164, 0x3f317218, v164
    v_mul_f32 v165, 0x3f317218, v165
    v_min_f32 v160, 0x7e800000, v160
    v_min_f32 v161, 0x7e800000, v161
    v_min_f32 v162, 0x7e800000, v162
    v_fmac_f32 v160, v163, v160
    v_fmac_f32 v161, v164, v161
    v_fmac_f32 v162, v165, v162
    v_add_f32 v160, 1.0, v160
    v_add_f32 v161, 1.0, v161
    v_add_f32 v162, 1.0, v162
    v_rcp_f32 v163, v160
    v_rcp_f32 v164, v161
    v_rcp_f32 v165, v162
    v_mul_f32 v166, v10, v163
    v_mul_f32 v167, v11, v164
    v_mul_f32 v168, v12, v165
    v_fma_f32 v10, -v166, v160, v10
    v_fma_f32 v11, -v167, v161, v11
    v_fma_f32 v12, -v168, v162, v12
    v_fma_f32 v10, v10, v163, v166
    v_fma_f32 v11, v11, v164, v167
    v_fma_f32 v12, v12, v165, v168
    v_cvt_pk_bf16_f32 v160, v10, v11
    v_cvt_pk_bf16_f32 v161, v12, v12
    ds_write_b16 v13, v160
    ds_write_b16_d16_hi v13, v160 offset:128
    ds_write_b16 v13, v161 offset:256
    ds_read2_b32 v[160:161], v14 offset0:0 offset1:4
    ds_read2_b32 v[162:163], v14 offset0:8 offset1:12
    ds_read2_b32 v[164:165], v14 offset0:16 offset1:20
    ds_read2_b32 v[166:167], v14 offset0:24 offset1:28
    ds_read2_b32 v[168:169], v14 offset0:32 offset1:36
    ds_read2_b32 v[170:171], v14 offset0:40 offset1:44
    ds_read2_b32 v[172:173], v14 offset0:48 offset1:52
    ds_read2_b32 v[174:175], v14 offset0:56 offset1:60
    ds_read2_b32 v[176:177], v14 offset0:64 offset1:68
    v_lshlrev_b32 v13, 5, v1
    v_lshl_add_u32 v13, v2, 4, v13
    s_waitcnt lgkmcnt(0)
    v_perm_b32 v180, v160, v160, v192
    v_perm_b32 v181, v160, v160, v193
    v_perm_b32 v182, v160, v160, v194
    v_perm_b32 v183, v160, v160, v195
    v_perm_b32 v184, v161, v161, v192
    v_perm_b32 v185, v161, v161, v193
    v_perm_b32 v186, v161, v161, v194
    v_perm_b32 v187, v161, v161, v195
    s_waitcnt vmcnt(15)
    v_mfma_f32_16x16x32_bf16 v[188:191], v[180:183], v[16:19], 0
    v_perm_b32 v180, v162, v162, v192
    v_perm_b32 v181, v162, v162, v193
    v_perm_b32 v182, v162, v162, v194
    v_perm_b32 v183, v162, v162, v195
    v_mfma_f32_16x16x32_bf16 v[188:191], v[184:187], v[20:23], v[188:191]
    v_perm_b32 v184, v163, v163, v192
    v_perm_b32 v185, v163, v163, v193
    v_perm_b32 v186, v163, v163, v194
    v_perm_b32 v187, v163, v163, v195
    v_mfma_f32_16x16x32_bf16 v[188:191], v[180:183], v[24:27], v[188:191]
    v_perm_b32 v180, v164, v164, v192
    v_perm_b32 v181, v164, v164, v193
    v_perm_b32 v182, v164, v164, v194
    v_perm_b32 v183, v164, v164, v195
    s_waitcnt vmcnt(12)
    v_mfma_f32_16x16x32_bf16 v[188:191], v[184:187], v[28:31], v[188:191]
    v_perm_b32 v184, v165, v165, v192
    v_perm_b32 v185, v165, v165, v193
    v_perm_b32 v186, v165, v165, v194
    v_perm_b32 v187, v165, v165, v195
    v_mfma_f32_16x16x32_bf16 v[188:191], v[180:183], v[32:35], v[188:191]
    v_perm_b32 v180, v166, v166, v192
    v_perm_b32 v181, v166, v166, v193
    v_perm_b32 v182, v166, v166, v194
    v_perm_b32 v183, v166, v166, v195
    v_mfma_f32_16x16x32_bf16 v[188:191], v[184:187], v[36:39], v[188:191]
    v_perm_b32 v184, v167, v167, v192
    v_perm_b32 v185, v167, v167, v193
    v_perm_b32 v186, v167, v167, v194
    v_perm_b32 v187, v167, v167, v195
    s_waitcnt vmcnt(9)
    v_mfma_f32_16x16x32_bf16 v[188:191], v[180:183], v[40:43], v[188:191]
    v_perm_b32 v180, v168, v168, v192
    v_perm_b32 v181, v168, v168, v193
    v_perm_b32 v182, v168, v168, v194
    v_perm_b32 v183, v168, v168, v195
    v_mfma_f32_16x16x32_bf16 v[188:191], v[184:187], v[44:47], v[188:191]
    v_perm_b32 v184, v169, v169, v192
    v_perm_b32 v185, v169, v169, v193
    v_perm_b32 v186, v169, v169, v194
    v_perm_b32 v187, v169, v169, v195
    v_mfma_f32_16x16x32_bf16 v[188:191], v[180:183], v[48:51], v[188:191]
    v_perm_b32 v180, v170, v170, v192
    v_perm_b32 v181, v170, v170, v193
    v_perm_b32 v182, v170, v170, v194
    v_perm_b32 v183, v170, v170, v195
    s_waitcnt vmcnt(6)
    v_mfma_f32_16x16x32_bf16 v[188:191], v[184:187], v[52:55], v[188:191]
    v_perm_b32 v184, v171, v171, v192
    v_perm_b32 v185, v171, v171, v193
    v_perm_b32 v186, v171, v171, v194
    v_perm_b32 v187, v171, v171, v195
    v_mfma_f32_16x16x32_bf16 v[188:191], v[180:183], v[56:59], v[188:191]
    v_perm_b32 v180, v172, v172, v192
    v_perm_b32 v181, v172, v172, v193
    v_perm_b32 v182, v172, v172, v194
    v_perm_b32 v183, v172, v172, v195
    v_mfma_f32_16x16x32_bf16 v[188:191], v[184:187], v[60:63], v[188:191]
    v_perm_b32 v184, v173, v173, v192
    v_perm_b32 v185, v173, v173, v193
    v_perm_b32 v186, v173, v173, v194
    v_perm_b32 v187, v173, v173, v195
    s_waitcnt vmcnt(3)
    v_mfma_f32_16x16x32_bf16 v[188:191], v[180:183], v[64:67], v[188:191]
    v_perm_b32 v180, v174, v174, v192
    v_perm_b32 v181, v174, v174, v193
    v_perm_b32 v182, v174, v174, v194
    v_perm_b32 v183, v174, v174, v195
    v_mfma_f32_16x16x32_bf16 v[188:191], v[184:187], v[68:71], v[188:191]
    v_perm_b32 v184, v175, v175, v192
    v_perm_b32 v185, v175, v175, v193
    v_perm_b32 v186, v175, v175, v194
    v_perm_b32 v187, v175, v175, v195
    v_mfma_f32_16x16x32_bf16 v[188:191], v[180:183], v[72:75], v[188:191]
    v_perm_b32 v180, v176, v176, v192
    v_perm_b32 v181, v176, v176, v193
    v_perm_b32 v182, v176, v176, v194
    v_perm_b32 v183, v176, v176, v195
    s_waitcnt vmcnt(0)
    v_mfma_f32_16x16x32_bf16 v[188:191], v[184:187], v[76:79], v[188:191]
    v_perm_b32 v184, v177, v177, v192
    v_perm_b32 v185, v177, v177, v193
    v_perm_b32 v186, v177, v177, v194
    v_perm_b32 v187, v177, v177, v195
    v_mfma_f32_16x16x32_bf16 v[188:191], v[180:183], v[80:83], v[188:191]
    s_nop 0
    v_mfma_f32_16x16x32_bf16 v[188:191], v[184:187], v[84:87], v[188:191]
    s_nop 7
    v_permlane32_swap_b32 v188, v180
    v_permlane32_swap_b32 v189, v181
    v_permlane32_swap_b32 v190, v182
    v_permlane32_swap_b32 v191, v183
    v_add_f32_dpp v188, v180, v188 row_ror:8 row_mask:0xf bank_mask:0xf
    v_add_f32_dpp v189, v181, v189 row_ror:8 row_mask:0xf bank_mask:0xf
    v_add_f32_dpp v190, v182, v190 row_ror:8 row_mask:0xf bank_mask:0xf
    v_add_f32_dpp v191, v183, v191 row_ror:8 row_mask:0xf bank_mask:0xf
    v_perm_b32 v188, v188, v196, s4
    v_perm_b32 v189, v189, v196, s5
    v_perm_b32 v190, v190, v196, s6
    v_perm_b32 v191, v191, v196, s7
    s_mov_b64 exec, s[78:79]
    buffer_store_dwordx4 v[188:191], v13, s[60:63], s70 offen sc1
    s_mov_b64 exec, -1
    s_cmp_eq_u32 s44, 2
    s_cbranch_scc1 L_qred1
    s_sub_u32 s45, s42, 9
    s_sub_u32 s46, s40, 4
    s_branch L_mlpw_noinit
L_w_qslow:
    buffer_store_dwordx4 v[188:191], v14, s[60:63], s69 offen sc1
    s_branch L_w_qst
L_wq_none:
    s_waitcnt lgkmcnt(0)
    s_add_u32 s43, s43, 0x01010101
    s_mov_b32 s4, 0x07060500
    s_bfe_u32 s92, s43, 0x80000
    s_mov_b32 s5, 0x07060501
    s_bfe_u32 s93, s43, 0x80008
    s_mov_b32 s6, 0x07060502
    s_bfe_u32 s94, s43, 0x80010
    s_mov_b32 s7, 0x07060503
    s_bfe_u32 s95, s43, 0x80018
    v_mov_b32 v196, s43
    v_bfe_u32 v13, v0, 3, 1
    v_mul_u32_u24 v13, 0x202, v13
    v_add_u32 v13, 0x100, v13
    v_and_b32 v14, 1, v0
    v_lshlrev_b32 v14, 4, v14
    v_lshlrev_b32 v13, v14, v13
    v_mov_b32 v15, 0x0c0c0000
    v_lshrrev_b32 v14, v14, v15
    v_or_b32 v13, v13, v14
    v_bfe_u32 v14, v0, 1, 2
    v_mov_b32 v15, 0x0c0c0c0c
    v_cmp_eq_u32 vcc, 0, v14
    s_nop 1
    v_cndmask_b32 v192, v15, v13, vcc
    v_cmp_eq_u32 vcc, 1, v14
    s_nop 1
    v_cndmask_b32 v193, v15, v13, vcc
    v_cmp_eq_u32 vcc, 2, v14
    s_nop 1
    v_cndmask_b32 v194, v15, v13, vcc
    v_cmp_eq_u32 vcc, 3, v14
    s_nop 1
    v_cndmask_b32 v195, v15, v13, vcc
    v_lshlrev_b32 v197, 3, v2
    v_lshrrev_b32 v197, v197, v196
    v_and_b32 v197, 0xff, v197
    v_lshlrev_b32 v251, 2, v8
L_qred:
L_qred1:
    s_lshl_b32 s70, s41, 15
    s_lshl_b32 s38, s40, 8
    s_add_u32 s70, s70, s38
    s_add_u32 s70, s70, 665600
    s_add_u32 s71, s70, 16384
    v_lshlrev_b32 v12, 12, v2
    v_lshl_add_u32 v12, v1, 4, v12
    s_lshl_b32 s47, s41, 11
    s_add_u32 s47, s47, s38
    s_add_u32 s47, s47, 77824
    v_mov_b32 v9, 3340
    s_mov_b32 s68, 0
L_qsr:
    ds_read_b32 v10, v9
    s_waitcnt lgkmcnt(0)
    v_cmp_le_u32 vcc, 1, v10
    s_cbranch_vccnz L_qsr_ok
    s_sleep 4
    s_add_u32 s68, s68, 1
    s_cmp_lt_u32 s68, 320000
    s_cbranch_scc1 L_qsr
L_qsr_ok:
    buffer_load_dwordx4 v[24:27], v12, s[60:63], s70 offen offset:0 sc1
    buffer_load_dwordx4 v[28:31], v12, s[60:63], s71 offen offset:0 sc1
    buffer_load_dwordx4 v[32:35], v12, s[60:63], s70 offen offset:2048 sc1
    buffer_load_dwordx4 v[36:39], v12, s[60:63], s71 offen offset:2048 sc1
    v_mul_u32_u24 v248, 1152, v2
    v_bfe_u32 v6, v0, 3, 1
    v_mul_u32_u24 v6, 36864, v6
    v_and_b32 v7, 7, v1
    v_lshl_add_u32 v6, v7, 4, v6
    v_add_u32 v248, v248, v6
    s_lshl_b32 s73, s41, 3
    s_add_u32 s73, s73, s40
    s_mul_i32 s73, s73, 73728
    s_lshl_b32 s39, s42, 7
    s_add_u32 s73, s73, s39
    s_mov_b32 s12, s16
    s_mov_b32 s13, s17
    s_mov_b32 s14, 4718592
    s_mov_b32 s15, 0x20000
    buffer_load_dwordx4 v[88:91], v248, s[12:15], s73 offen nt
    s_add_u32 s73, s73, 4608
    buffer_load_dwordx4 v[92:95], v248, s[12:15], s73 offen nt
    s_add_u32 s73, s73, 4608
    buffer_load_dwordx4 v[96:99], v248, s[12:15], s73 offen nt
    s_add_u32 s73, s73, 4608
    buffer_load_dwordx4 v[100:103], v248, s[12:15], s73 offen nt
    s_add_u32 s73, s73, 4608
    s_cmp_eq_u32 s40, 6
    s_cbranch_scc0 L_qred2
    s_sleep 24
    v_min_u32 v13, 8, v0
    v_lshlrev_b32 v13, 7, v13
    s_lshl_b32 s74, s41, 11
    s_add_u32 s74, s74, 933888
    buffer_load_dwordx4 v[200:203], v13, s[60:63], s74 offen sc1
    s_getreg_b32 s75, hwreg(HW_REG_XCC_ID, 0, 4)
    s_lshl_b32 s75, s75, 8
    s_waitcnt vmcnt(0)
    v_xor_b32 v200, s92, v200
    v_xor_b32 v201, s93, v201
    v_xor_b32 v202, s94, v202
    v_xor_b32 v203, s95, v203
    v_xor_b32 v200, s75, v200
    v_or3_b32 v14, v201, v202, v203
    v_or_b32 v14, v14, v200
    s_or_b32 s75, s75, 0x1000
    v_cmp_ne_u32 vcc, 0, v14
    s_cmp_eq_u64 vcc, 0
    s_cselect_b32 s75, s75, 0
    v_mov_b32 v13, 0
    v_mov_b32 v14, s75
    ds_write_b32 v13, v14 offset:3332
    v_mov_b32 v14, 1
    ds_write_b32 v13, v14 offset:3336
L_qred2:
    v_mov_b32 v9, 3336
    s_mov_b32 s68, 0
L_gor:
    ds_read_b32 v10, v9
    s_waitcnt lgkmcnt(0)
    v_cmp_le_u32 vcc, 1, v10
    s_cbranch_vccnz L_gor_ok
    s_sleep 8
    s_add_u32 s68, s68, 1
    s_cmp_lt_u32 s68, 320000
    s_cbranch_scc1 L_gor
L_gor_ok:
    v_mov_b32 v9, 3332
    ds_read_b32 v9, v9
    s_waitcnt lgkmcnt(0)
    v_readfirstlane_b32 s75, v9
    s_mov_b32 s68, 0
L_poll_14:
    buffer_load_dwordx4 v[24:27], v12, s[60:63], s70 offen offset:0 sc1
    buffer_load_dwordx4 v[28:31], v12, s[60:63], s71 offen offset:0 sc1
    buffer_load_dwordx4 v[32:35], v12, s[60:63], s70 offen offset:2048 sc1
    buffer_load_dwordx4 v[36:39], v12, s[60:63], s71 offen offset:2048 sc1
    s_waitcnt vmcnt(3)
    v_xor_b32 v24, s92, v24
    v_xor_b32 v25, s93, v25
    v_xor_b32 v26, s94, v26
    v_xor_b32 v27, s95, v27
    v_or3_b32 v15, v24, v25, v26
    s_waitcnt vmcnt(2)
    v_xor_b32 v28, s92, v28
    v_xor_b32 v29, s93, v29
    v_xor_b32 v30, s94, v30
    v_xor_b32 v31, s95, v31
    v_or3_b32 v15, v15, v27, v28
    v_or3_b32 v15, v15, v29, v30
    s_waitcnt vmcnt(1)
    v_xor_b32 v32, s92, v32
    v_xor_b32 v33, s93, v33
    v_xor_b32 v34, s94, v34
    v_xor_b32 v35, s95, v35
    v_or3_b32 v15, v15, v31, v32
    v_or3_b32 v15, v15, v33, v34
    s_waitcnt vmcnt(0)
    v_xor_b32 v36, s92, v36
    v_xor_b32 v37, s93, v37
    v_xor_b32 v38, s94, v38
    v_xor_b32 v39, s95, v39
    v_or3_b32 v15, v15, v35, v36
    v_or3_b32 v15, v15, v37, v38
    v_or_b32 v15, v15, v39
    v_and_b32 v15, 0xff, v15
    v_cmp_ne_u32 vcc, 0, v15
    s_cbranch_vccnz L_poll_14_r
L_poll_14_ok:
    v_pk_add_f32 v[24:25], v[24:25], v[28:29]
    v_pk_add_f32 v[26:27], v[26:27], v[30:31]
    v_pk_add_f32 v[32:33], v[32:33], v[36:37]
    v_pk_add_f32 v[34:35], v[34:35], v[38:39]
    v_pk_add_f32 v[24:25], v[24:25], v[32:33]
    v_pk_add_f32 v[26:27], v[26:27], v[34:35]
    s_nop 1
    v_permlane32_swap_b32 v24, v26
    v_permlane32_swap_b32 v25, v27
    v_add_f32 v24, v24, v26
    v_add_f32 v25, v25, v27
    s_nop 1
    v_permlane16_swap_b32 v24, v25
    v_add_f32 v24, v24, v25
    v_cvt_pk_bf16_f32 v24, v24, v24
    v_and_b32 v24, 0xffff0000, v24
    v_or3_b32 v24, v24, v197, s75
    buffer_store_dword v24, v251, s[60:63], s47 offen
    v_mov_b32 v9, 3328
    v_mov_b32 v10, 1
    s_mov_b64 exec, 1
    ds_add_u32 v9, v10
    s_mov_b64 exec, -1
    v_mov_b32 v11, 3328
    s_mov_b32 s68, 0
L_hf8r:
    ds_read_b32 v14, v11
    s_waitcnt lgkmcnt(0)
    v_cmp_le_u32 vcc, 8, v14
    s_cbranch_vccnz L_hf8r_ok
    s_sleep 1
    s_add_u32 s68, s68, 1
    s_cmp_lt_u32 s68, 320000
    s_cbranch_scc1 L_hf8r
L_hf8r_ok:
    buffer_load_dwordx4 v[104:107], v248, s[12:15], s73 offen nt
    s_add_u32 s73, s73, 4608
    buffer_load_dwordx4 v[108:111], v248, s[12:15], s73 offen nt
    s_add_u32 s73, s73, 4608
    buffer_load_dwordx4 v[112:115], v248, s[12:15], s73 offen nt
    s_add_u32 s73, s73, 4608
    buffer_load_dwordx4 v[116:119], v248, s[12:15], s73 offen nt
    s_branch L_w_wod
L_q_again:
    buffer_store_dword v24, v251, s[60:63], s47 offen sc1
    s_branch L_q_again_done
L_w_m8:
    v_mov_b32 v9, 3340
    v_mov_b32 v10, 1
    ds_write_b32 v9, v10
    s_branch L_qred
L_w_67:
    s_cmp_lt_u32 s42, 8
    s_cbranch_scc0 L_qred
    s_cmp_eq_u32 s40, 6
    s_cbranch_scc0 L_w_wo
    v_mov_b32 v11, 3336
    s_mov_b32 s68, 0
L_gow6:
    ds_read_b32 v14, v11
    s_waitcnt lgkmcnt(0)
    v_cmp_le_u32 vcc, 1, v14
    s_cbranch_vccnz L_gow6_ok
    s_sleep 4
    s_add_u32 s68, s68, 1
    s_cmp_lt_u32 s68, 320000
    s_cbranch_scc1 L_gow6
L_gow6_ok:
    v_min_u32 v13, 8, v0
    v_lshlrev_b32 v13, 7, v13
    s_lshl_b32 s74, s41, 11
    s_add_u32 s74, s74, 933888
    buffer_load_dwordx4 v[200:203], v13, s[60:63], s74 offen sc1
    s_getreg_b32 s75, hwreg(HW_REG_XCC_ID, 0, 4)
    s_lshl_b32 s75, s75, 8
    s_waitcnt vmcnt(0)
    v_xor_b32 v200, s92, v200
    v_xor_b32 v201, s93, v201
    v_xor_b32 v202, s94, v202
    v_xor_b32 v203, s95, v203
    v_xor_b32 v200, s75, v200
    v_or3_b32 v14, v201, v202, v203
    v_or_b32 v14, v14, v200
    s_or_b32 s75, s75, 0x1000
    v_cmp_ne_u32 vcc, 0, v14
    s_cmp_eq_u64 vcc, 0
    s_cselect_b32 s75, s75, 0
    v_mov_b32 v13, 0
    v_mov_b32 v14, s75
    ds_write_b32 v13, v14 offset:3332
    s_branch L_w_wo
L_w_ln:
    s_cmp_lt_u32 s42, 8
    s_cbranch_scc0 L_qred
    s_setprio 3
    s_waitcnt vmcnt(0)
    v_lshlrev_b32 v16, 16, v152
    v_and_b32 v17, 0xffff0000, v152
    v_lshlrev_b32 v18, 16, v153
    v_and_b32 v19, 0xffff0000, v153
    v_lshlrev_b32 v20, 16, v154
    v_and_b32 v21, 0xffff0000, v154
    v_lshlrev_b32 v22, 16, v155
    v_and_b32 v23, 0xffff0000, v155
    v_lshlrev_b32 v24, 16, v156
    v_and_b32 v25, 0xffff0000, v156
    v_add_f32 v10, v16, v17
    v_mul_f32 v11, v16, v16
    v_fmac_f32 v11, v17, v17
    v_add_f32 v10, v10, v18
    v_fmac_f32 v11, v18, v18
    v_add_f32 v10, v10, v19
    v_fmac_f32 v11, v19, v19
    v_add_f32 v10, v10, v20
    v_fmac_f32 v11, v20, v20
    v_add_f32 v10, v10, v21
    v_fmac_f32 v11, v21, v21
    v_add_f32 v10, v10, v22
    v_fmac_f32 v11, v22, v22
    v_add_f32 v10, v10, v23
    v_fmac_f32 v11, v23, v23
    v_add_f32 v10, v10, v24
    v_fmac_f32 v11, v24, v24
    v_add_f32 v10, v10, v25
    v_fmac_f32 v11, v25, v25
    s_nop 0
    v_add_f32_dpp v10, v10, v10 quad_perm:[1,0,3,2] row_mask:0xf bank_mask:0xf
    v_add_f32_dpp v11, v11, v11 quad_perm:[1,0,3,2] row_mask:0xf bank_mask:0xf
    s_nop 0
    v_add_f32_dpp v10, v10, v10 quad_perm:[2,3,0,1] row_mask:0xf bank_mask:0xf
    v_add_f32_dpp v11, v11, v11 quad_perm:[2,3,0,1] row_mask:0xf bank_mask:0xf
    s_nop 0
    v_add_f32_dpp v10, v10, v10 row_half_mirror row_mask:0xf bank_mask:0xf
    v_add_f32_dpp v11, v11, v11 row_half_mirror row_mask:0xf bank_mask:0xf
    s_nop 0
    v_add_f32_dpp v10, v10, v10 row_mirror row_mask:0xf bank_mask:0xf
    v_add_f32_dpp v11, v11, v11 row_mirror row_mask:0xf bank_mask:0xf
    v_mov_b32 v12, v10
    v_mov_b32 v13, v11
    s_nop 0
    v_permlane16_swap_b32 v12, v10
    v_permlane16_swap_b32 v13, v11
    v_add_f32 v10, v10, v12
    v_add_f32 v11, v11, v13
    v_mov_b32 v12, v10
    v_mov_b32 v13, v11
    s_nop 0
    v_permlane32_swap_b32 v12, v10
    v_permlane32_swap_b32 v13, v11
    v_add_f32 v10, v10, v12
    v_add_f32 v11, v11, v13
    v_mul_f32 v10, 0x3ae38e39, v10
    v_mul_f32 v11, 0x3ae38e39, v11
    v_fma_f32 v11, -v10, v10, v11
    v_cvt_pk_bf16_f32 v12, v10, v11
    v_lshlrev_b32 v10, 16, v12
    v_and_b32 v11, 0xffff0000, v12
    v_add_f32 v11, 0x3727c5ac, v11
    v_cvt_pk_bf16_f32 v11, v11, v11
    v_and_b32 v11, 0xffff0000, v11
    v_sqrt_f32 v11, v11
    s_nop 0
    v_cvt_pk_bf16_f32 v11, v11, v11
    v_and_b32 v11, 0xffff0000, v11
    v_rcp_f32 v11, v11
    v_lshlrev_b32 v157, 16, v157
    v_lshlrev_b32 v158, 16, v158
    v_sub_f32 v157, v157, v10
    v_sub_f32 v158, v158, v10
    v_cvt_pk_bf16_f32 v12, v157, v158
    v_lshlrev_b32 v157, 16, v12
    v_and_b32 v158, 0xffff0000, v12
    v_mul_f32 v157, v157, v11
    v_mul_f32 v158, v158, v11
    v_cvt_pk_bf16_f32 v12, v157, v158
    v_lshlrev_b32 v157, 16, v12
    v_and_b32 v158, 0xffff0000, v12
    s_mul_i32 s38, s42, 288
    s_add_u32 s70, s38, 4096
    s_add_u32 s71, s38, 59392
    v_mul_u32_u24 v12, 13824, v2
    v_lshl_add_u32 v12, v1, 4, v12
    v_mul_u32_u24 v13, 4608, v2
    v_lshl_add_u32 v13, v1, 4, v13
    v_and_b32 v14, 1, v1
    v_lshlrev_b32 v14, 4, v14
    v_bfe_u32 v15, v1, 1, 1
    v_mul_u32_u24 v15, 2304, v15
    v_add3_u32 v14, v14, v15, 64
    v_add_u32 v14, 192, v14
    v_mul_u32_u24 v15, 13824, v2
    v_mul_u32_u24 v10, 4608, v2
    v_add_u32 v10, 55296, v10
    v_and_b32 v11, 4, v1
    v_cmp_ne_u32 vcc, 0, v11
    s_nop 1
    v_cndmask_b32 v15, v15, v10, vcc
    v_add_u32 v14, v14, v15
    v_add_u32 v10, 512, v251
    v_mov_b32 v11, 3336
    s_mov_b32 s68, 0
L_gow5:
    ds_read_b32 v9, v11
    s_waitcnt lgkmcnt(0)
    v_cmp_le_u32 vcc, 1, v9
    s_cbranch_vccnz L_gow5_ok
    s_sleep 2
    s_add_u32 s68, s68, 1
    s_cmp_lt_u32 s68, 320000
    s_cbranch_scc1 L_gow5
L_gow5_ok:
    v_mov_b32 v11, 3328
    v_mov_b32 v9, 1
    buffer_load_dwordx4 v[200:203], v12, s[60:63], s70 offen sc1
    buffer_load_dwordx4 v[204:207], v12, s[60:63], s70 offen offset:2304 sc1
    buffer_load_dwordx4 v[208:211], v13, s[60:63], s71 offen sc1
    buffer_load_dwordx4 v[212:215], v13, s[60:63], s71 offen offset:2304 sc1
    buffer_load_dwordx4 v[216:219], v14, s[60:63], s70 offen sc1
    s_sleep 8
    buffer_load_dwordx4 v[16:19], v12, s[60:63], s70 offen sc1
    buffer_load_dwordx4 v[20:23], v12, s[60:63], s70 offen offset:2304 sc1
    buffer_load_dwordx4 v[24:27], v13, s[60:63], s71 offen sc1
    buffer_load_dwordx4 v[28:31], v13, s[60:63], s71 offen offset:2304 sc1
    buffer_load_dwordx4 v[32:35], v14, s[60:63], s70 offen sc1
    s_mov_b32 s68, 0
L_h_loop:
    s_waitcnt vmcnt(9)
    v_xor_b32 v200, s92, v200
    v_xor_b32 v201, s93, v201
    v_xor_b32 v202, s94, v202
    v_xor_b32 v203, s95, v203
    v_or3_b32 v15, v200, v201, v202
    s_waitcnt vmcnt(8)
    v_xor_b32 v204, s92, v204
    v_xor_b32 v205, s93, v205
    v_xor_b32 v206, s94, v206
    v_xor_b32 v207, s95, v207
    v_or3_b32 v15, v15, v203, v204
    v_or3_b32 v15, v15, v205, v206
    s_waitcnt vmcnt(7)
    v_xor_b32 v208, s92, v208
    v_xor_b32 v209, s93, v209
    v_xor_b32 v210, s94, v210
    v_xor_b32 v211, s95, v211
    v_or3_b32 v15, v15, v207, v208
    v_or3_b32 v15, v15, v209, v210
    s_waitcnt vmcnt(6)
    v_xor_b32 v212, s92, v212
    v_xor_b32 v213, s93, v213
    v_xor_b32 v214, s94, v214
    v_xor_b32 v215, s95, v215
    v_or3_b32 v15, v15, v211, v212
    v_or3_b32 v15, v15, v213, v214
    s_waitcnt vmcnt(5)
    v_xor_b32 v216, s92, v216
    v_xor_b32 v217, s93, v217
    v_xor_b32 v218, s94, v218
    v_xor_b32 v219, s95, v219
    v_or3_b32 v15, v15, v215, v216
    v_or3_b32 v15, v15, v217, v218
    v_or_b32 v15, v15, v219
    v_and_b32 v15, 0xff, v15
    v_cmp_ne_u32 vcc, 0, v15
    s_cbranch_vccz L_h_ok
    buffer_load_dwordx4 v[200:203], v12, s[60:63], s70 offen sc1
    buffer_load_dwordx4 v[204:207], v12, s[60:63], s70 offen offset:2304 sc1
    buffer_load_dwordx4 v[208:211], v13, s[60:63], s71 offen sc1
    buffer_load_dwordx4 v[212:215], v13, s[60:63], s71 offen offset:2304 sc1
    buffer_load_dwordx4 v[216:219], v14, s[60:63], s70 offen sc1
    s_waitcnt vmcnt(9)
    v_xor_b32 v16, s92, v16
    v_xor_b32 v17, s93, v17
    v_xor_b32 v18, s94, v18
    v_xor_b32 v19, s95, v19
    v_or3_b32 v15, v16, v17, v18
    s_waitcnt vmcnt(8)
    v_xor_b32 v20, s92, v20
    v_xor_b32 v21, s93, v21
    v_xor_b32 v22, s94, v22
    v_xor_b32 v23, s95, v23
    v_or3_b32 v15, v15, v19, v20
    v_or3_b32 v15, v15, v21, v22
    s_waitcnt vmcnt(7)
    v_xor_b32 v24, s92, v24
    v_xor_b32 v25, s93, v25
    v_xor_b32 v26, s94, v26
    v_xor_b32 v27, s95, v27
    v_or3_b32 v15, v15, v23, v24
    v_or3_b32 v15, v15, v25, v26
    s_waitcnt vmcnt(6)
    v_xor_b32 v28, s92, v28
    v_xor_b32 v29, s93, v29
    v_xor_b32 v30, s94, v30
    v_xor_b32 v31, s95, v31
    v_or3_b32 v15, v15, v27, v28
    v_or3_b32 v15, v15, v29, v30
    s_waitcnt vmcnt(5)
    v_xor_b32 v32, s92, v32
    v_xor_b32 v33, s93, v33
    v_xor_b32 v34, s94, v34
    v_xor_b32 v35, s95, v35
    v_or3_b32 v15, v15, v31, v32
    v_or3_b32 v15, v15, v33, v34
    v_or_b32 v15, v15, v35
    v_and_b32 v15, 0xff, v15
    v_cmp_ne_u32 vcc, 0, v15
    s_cbranch_vccz L_h_ok2
    buffer_load_dwordx4 v[16:19], v12, s[60:63], s70 offen sc1
    buffer_load_dwordx4 v[20:23], v12, s[60:63], s70 offen offset:2304 sc1
    buffer_load_dwordx4 v[24:27], v13, s[60:63], s71 offen sc1
    buffer_load_dwordx4 v[28:31], v13, s[60:63], s71 offen offset:2304 sc1
    buffer_load_dwordx4 v[32:35], v14, s[60:63], s70 offen sc1
    s_add_u32 s68, s68, 1
    s_cmp_lt_u32 s68, 40000
    s_cbranch_scc1 L_h_loop
L_h_ok2:
    v_add_f32_dpp v32, v32, v32 row_ror:12 row_mask:0xf bank_mask:0xf
    v_add_f32_dpp v33, v33, v33 row_ror:12 row_mask:0xf bank_mask:0xf
    v_add_f32_dpp v34, v34, v34 row_ror:12 row_mask:0xf bank_mask:0xf
    v_add_f32_dpp v35, v35, v35 row_ror:12 row_mask:0xf bank_mask:0xf
    v_pk_add_f32 v[16:17], v[16:17], v[24:25]
    v_pk_add_f32 v[18:19], v[18:19], v[26:27]
    v_pk_add_f32 v[20:21], v[20:21], v[28:29]
    v_pk_add_f32 v[22:23], v[22:23], v[30:31]
    v_permlane32_swap_b32 v32, v34
    v_permlane32_swap_b32 v33, v35
    v_add_f32 v32, v32, v34
    v_add_f32 v33, v33, v35
    s_nop 1
    v_permlane16_swap_b32 v32, v33
    v_add_f32 v32, v32, v33
    v_permlane32_swap_b32 v16, v18
    v_permlane32_swap_b32 v17, v19
    v_add_f32 v16, v16, v18
    v_add_f32 v17, v17, v19
    s_nop 1
    v_permlane16_swap_b32 v16, v17
    v_add_f32 v16, v16, v17
    v_permlane32_swap_b32 v20, v22
    v_permlane32_swap_b32 v21, v23
    v_add_f32 v20, v20, v22
    v_add_f32 v21, v21, v23
    s_nop 1
    v_permlane16_swap_b32 v20, v21
    v_add_f32 v20, v20, v21
    v_mov_b32_dpp v33, v32 row_ror:14 row_mask:0xf bank_mask:0xf
    v_cvt_pk_bf16_f32 v14, v20, v33
    v_lshlrev_b32 v20, 16, v14
    v_and_b32 v33, 0xffff0000, v14
    v_cvt_pk_bf16_f32 v15, v16, v32
    v_lshlrev_b32 v16, 16, v15
    v_and_b32 v32, 0xffff0000, v15
    v_add_f32 v20, 1.0, v20
    v_add_f32 v33, 1.0, v33
    v_cvt_pk_bf16_f32 v14, v20, v33
    v_lshlrev_b32 v20, 16, v14
    v_and_b32 v33, 0xffff0000, v14
    v_mul_f32 v20, v20, v157
    v_mul_f32 v33, v33, v158
    v_cvt_pk_bf16_f32 v14, v20, v33
    v_lshlrev_b32 v20, 16, v14
    v_and_b32 v33, 0xffff0000, v14
    v_add_f32 v20, v20, v16
    v_add_f32 v33, v33, v32
    v_cvt_pk_bf16_f32 v20, v20, v20
    v_cvt_pk_bf16_f32 v33, v33, v33
    ds_write_b32 v10, v20
    ds_write_b32 v10, v33 offset:256
    ds_write_b32 v11, v9
    s_branch L_h_done
L_h_ok:
    v_add_f32_dpp v216, v216, v216 row_ror:12 row_mask:0xf bank_mask:0xf
    v_add_f32_dpp v217, v217, v217 row_ror:12 row_mask:0xf bank_mask:0xf
    v_add_f32_dpp v218, v218, v218 row_ror:12 row_mask:0xf bank_mask:0xf
    v_add_f32_dpp v219, v219, v219 row_ror:12 row_mask:0xf bank_mask:0xf
    v_pk_add_f32 v[200:201], v[200:201], v[208:209]
    v_pk_add_f32 v[202:203], v[202:203], v[210:211]
    v_pk_add_f32 v[204:205], v[204:205], v[212:213]
    v_pk_add_f32 v[206:207], v[206:207], v[214:215]
    v_permlane32_swap_b32 v216, v218
    v_permlane32_swap_b32 v217, v219
    v_add_f32 v216, v216, v218
    v_add_f32 v217, v217, v219
    s_nop 1
    v_permlane16_swap_b32 v216, v217
    v_add_f32 v216, v216, v217
    v_permlane32_swap_b32 v200, v202
    v_permlane32_swap_b32 v201, v203
    v_add_f32 v200, v200, v202
    v_add_f32 v201, v201, v203
    s_nop 1
    v_permlane16_swap_b32 v200, v201
    v_add_f32 v200, v200, v201
    v_permlane32_swap_b32 v204, v206
    v_permlane32_swap_b32 v205, v207
    v_add_f32 v204, v204, v206
    v_add_f32 v205, v205, v207
    s_nop 1
    v_permlane16_swap_b32 v204, v205
    v_add_f32 v204, v204, v205
    v_mov_b32_dpp v217, v216 row_ror:14 row_mask:0xf bank_mask:0xf
    v_cvt_pk_bf16_f32 v14, v204, v217
    v_lshlrev_b32 v204, 16, v14
    v_and_b32 v217, 0xffff0000, v14
    v_cvt_pk_bf16_f32 v15, v200, v216
    v_lshlrev_b32 v200, 16, v15
    v_and_b32 v216, 0xffff0000, v15
    v_add_f32 v204, 1.0, v204
    v_add_f32 v217, 1.0, v217
    v_cvt_pk_bf16_f32 v14, v204, v217
    v_lshlrev_b32 v204, 16, v14
    v_and_b32 v217, 0xffff0000, v14
    v_mul_f32 v204, v204, v157
    v_mul_f32 v217, v217, v158
    v_cvt_pk_bf16_f32 v14, v204, v217
    v_lshlrev_b32 v204, 16, v14
    v_and_b32 v217, 0xffff0000, v14
    v_add_f32 v204, v204, v200
    v_add_f32 v217, v217, v216
    v_cvt_pk_bf16_f32 v204, v204, v204
    v_cvt_pk_bf16_f32 v217, v217, v217
    ds_write_b32 v10, v204
    ds_write_b32 v10, v217 offset:256
    ds_write_b32 v11, v9
L_h_done:
    s_setprio 0
    s_branch L_w_wo
L_poll_7_r:
    s_sleep 2
    s_add_u32 s68, s68, 1
    s_cmp_lt_u32 s68, 40000
    s_cbranch_scc1 L_poll_7
    s_branch L_poll_7_ok
L_poll_8_r:
    s_add_u32 s68, s68, 1
    s_cmp_lt_u32 s68, 40000
    s_cbranch_scc1 L_poll_8
    s_branch L_poll_8_ok
L_poll_9_r:
    s_sleep 1
    s_add_u32 s68, s68, 1
    s_cmp_lt_u32 s68, 40000
    s_cbranch_scc1 L_poll_9
    s_branch L_poll_9_ok
L_poll_10_r:
    s_add_u32 s68, s68, 1
    s_cmp_lt_u32 s68, 40000
    s_cbranch_scc1 L_poll_10
    s_branch L_poll_10_ok
L_cstr_12:
    s_mov_b32 s38, 8704
    s_mov_b32 s39, 13312
    buffer_load_dwordx4 v[40:43], v54, s[60:63], s38 offen sc1
    buffer_load_dwordx4 v[44:47], v54, s[60:63], s38 offen offset:2304 sc1
    buffer_load_dwordx4 v[48:51], v54, s[60:63], s39 offen sc1
    s_add_u32 s68, s68, 1
    s_cmp_lt_u32 s68, 40000
    s_waitcnt vmcnt(0)
    s_cbranch_scc1 L_cst_11
    s_branch L_cst_11_ok
L_poll_13_r:
    s_add_u32 s68, s68, 1
    s_cmp_lt_u32 s68, 40000
    s_cbranch_scc1 L_poll_13
    s_branch L_poll_13_ok
L_poll_14_r:
    s_sleep 1
    s_add_u32 s68, s68, 1
    s_cmp_lt_u32 s68, 40000
    s_cbranch_scc1 L_poll_14
    s_branch L_poll_14_ok
L_end:
    s_endpgm
.section .rodata,"a"
.p2align 6
.amdhsa_kernel adaLN_cond__sliding_block_cached__mixer_channel_mlp__decode_kernel
  .amdhsa_next_free_vgpr 256
  .amdhsa_next_free_sgpr 102
  .amdhsa_accum_offset 256
  .amdhsa_group_segment_fixed_size 0
  .amdhsa_kernarg_size 120
  .amdhsa_user_sgpr_count 2
  .amdhsa_user_sgpr_kernarg_segment_ptr 1
  .amdhsa_system_sgpr_workgroup_id_x 1
  .amdhsa_float_denorm_mode_32 3
.end_amdhsa_kernel
```
